```python
import torch

def _softmax(x, axis=-1):
    return torch.softmax(x, dim=axis)

def _gelu(x):
    return torch.nn.functional.gelu(x, approximate='tanh')

def _silu(x):
    return torch.nn.functional.silu(x)

def _sigmoid(x):
    return torch.sigmoid(x)

def _layernorm(x, axis=-1, eps=1e-05):
    m = x.mean(dim=axis, keepdim=True)
    v = x.var(dim=axis, keepdim=True, unbiased=False)
    return (x - m) / torch.sqrt(v + eps)

def _scatter_add(tgt, idx, src, axis=0):
    return tgt.clone().index_add_(axis, idx, src)

def _segment_sum(src, seg, n):
    out = torch.zeros((n,) + src.shape[1:], dtype=src.dtype)
    return out.index_add_(0, seg, src)

def _pad(x, pw):
    flat = tuple((v for pair in reversed(pw) for v in pair))
    return torch.nn.functional.pad(x, flat)
kernel_name = 'adaLN_cond__sliding_block_cached__glu_gated_glu__decode'

def setup_inputs():

    _w = lambda a: (lambda t: t.to(torch.bfloat16) if t.is_floating_point() else t)(torch.as_tensor(a))

    def _A_setup():
        B, Sq, D = (4, 1, 512)
        Hq, Hkv, Sk, Dh = (32, 8, 8192, 128)
        assert Hq % Hkv == 0, (Hq, Hkv)
        return {'x': _w((lambda *s: torch.randn(*s, dtype=torch.bfloat16) * 0.05)(B, Sq, D)), 'k_cache': _w((lambda *s: torch.randn(*s, dtype=torch.bfloat16) * 3.2)(B, Hkv, Sk, Dh)), 'v_cache': _w((lambda *s: torch.randn(*s, dtype=torch.bfloat16) * 0.4)(B, Hkv, Sk, Dh)), 'wq': _w((lambda *s: torch.randn(*s, dtype=torch.bfloat16) * 3.2)(D, Hq * Dh) * D ** (-0.5)), 'wo': _w((lambda *s: torch.randn(*s, dtype=torch.bfloat16) * 0.4)(Hq * Dh, D) * (Hq * Dh) ** (-0.5))}
    _A_in = _A_setup()

    def _B_setup():
        B, S, D, F = (4, 1, 512, 1792)
        return {'x': _w((lambda *s: torch.randn(*s, dtype=torch.bfloat16) * 0.05)(B, S, D)), 'w_gate': _w((lambda *s: torch.randn(*s, dtype=torch.bfloat16) * 0.05)(D, F)), 'w_up': _w((lambda *s: torch.randn(*s, dtype=torch.bfloat16) * 0.05)(D, F)), 'w_down': _w((lambda *s: torch.randn(*s, dtype=torch.bfloat16) * 0.05)(F, D))}
    _B_in = _B_setup()
    return {'A_x': _A_in['x'], 'A_k_cache': _A_in['k_cache'], 'A_v_cache': _A_in['v_cache'], 'A_wq': _A_in['wq'], 'A_wo': _A_in['wo'], 'B_x': _B_in['x'], 'B_w_gate': _B_in['w_gate'], 'B_w_up': _B_in['w_up'], 'B_w_down': _B_in['w_down'], 'c': _w((lambda *s: torch.randn(*s, dtype=torch.bfloat16) * 0.1)(4, 512) * 8.0), 'w_mod': _w((lambda *s: torch.randn(*s, dtype=torch.bfloat16) * 0.1)(512, 6 * 512) * 512 ** (-0.5) * 8.0)}

def reference(A_x, A_k_cache, A_v_cache, A_wq, A_wo, B_x, B_w_gate, B_w_up, B_w_down, c, w_mod):

    def _A_ref(x, k_cache, v_cache, wq, wo):
        B, Sq, D = x.shape
        Hq, Dh = (32, 128)
        Hkv, Sk = (k_cache.shape[1], k_cache.shape[2])
        W = min(4096, max(256, Sk // 4))
        rep = Hq // Hkv
        q = (lambda x, *d: x.permute(*d))((x @ wq).reshape(B, Sq, Hq, Dh), 0, 2, 1, 3)
        k = (lambda x, n, axis: torch.repeat_interleave(x, n, dim=axis))(k_cache[:, :, Sk - W:, :], rep, axis=1)
        v = (lambda x, n, axis: torch.repeat_interleave(x, n, dim=axis))(v_cache[:, :, Sk - W:, :], rep, axis=1)
        scores = torch.einsum('bhqd,bhkd->bhqk', q, k) * Dh ** (-0.5)
        p = _softmax(scores, axis=-1)
        o = torch.einsum('bhqk,bhkd->bhqd', p, v)
        return (lambda x, *d: x.permute(*d))(o, 0, 2, 1, 3).reshape(B, Sq, Hq * Dh) @ wo

    def _B_ref(x, w_gate, w_up, w_down):
        g = torch.einsum('bsd,df->bsf', x, w_gate)
        u = torch.einsum('bsd,df->bsf', x, w_up)
        h = _sigmoid(g) * u
        return torch.einsum('bsf,fd->bsd', h, w_down)
    x = A_x
    mod = (_silu(c) @ w_mod).reshape(c.shape[0], 6, 1, -1)
    sa, ca, ga, sb, cb, gb = (mod[:, 0].clone(), mod[:, 1].clone(), mod[:, 2].clone(), mod[:, 3].clone(), mod[:, 4].clone(), mod[:, 5].clone())
    h = _layernorm(x, axis=-1) * (1 + ca) + sa
    x = x + ga * _A_ref(h, A_k_cache, A_v_cache, A_wq, A_wo)
    h = _layernorm(x, axis=-1) * (1 + cb) + sb
    x = x + gb * _B_ref(h, B_w_gate, B_w_up, B_w_down)
    return x
```

```asm
; @launch grid=(256,1,1) block=(512,1,1) lds=111680
.amdgcn_target "amdgcn-amd-amdhsa--gfx950"
.text
.globl adaLN_cond__sliding_block_cached__glu_gated_glu__decode_kernel
.p2align 8
.type adaLN_cond__sliding_block_cached__glu_gated_glu__decode_kernel,@function
adaLN_cond__sliding_block_cached__glu_gated_glu__decode_kernel:
    s_load_dwordx16 s[8:23], s[0:1], 0
    s_load_dwordx8 s[24:31], s[0:1], 64
    s_load_dwordx2 s[32:33], s[0:1], 104
    s_cmpk_ge_u32 s2, 256
    s_cbranch_scc1 L_end
    v_lshrrev_b32 v1, 6, v0
    s_and_b32 s4, s2, 7
    v_readfirstlane_b32 s3, v1
    s_lshr_b32 s5, s2, 3
    s_and_b32 s6, s5, 3
    s_lshr_b32 s7, s5, 2
    v_bfe_u32 v7, v0, 4, 2
    v_and_b32 v8, 15, v0
    v_and_b32 v9, 7, v0
    v_bfe_u32 v10, v0, 3, 1
    s_and_b32 s54, s3, 3
    s_cmp_gt_u32 s3, 1
    s_cbranch_scc1 L_other
    s_and_b32 s98, s4, 6
    s_add_u32 s98, s98, s54
    s_and_b32 s97, s4, 1
    s_lshl1_add_u32 s97, s5, s97
    s_sub_u32 s97, s97, 8
    s_cmp_lt_u32 s5, 8
    s_cselect_b32 s98, s4, s98
    s_cselect_b32 s97, s5, s97
    s_cselect_b32 s63, s54, 0
    s_lshl1_add_u32 s60, s6, s54
    s_lshl2_add_u32 s61, s4, s7
    s_sub_u32 s61, s61, 4
    s_movk_i32 s58, 6144
    s_cmp_ge_u32 s5, 16
    s_cselect_b32 s98, s60, s98
    s_cselect_b32 s97, s61, s97
    s_cselect_b32 s58, 0x2000, s58
    s_mul_i32 s38, s58, 512
    s_mul_i32 s51, s98, s58
    s_mul_i32 s52, s98, 128
    v_mul_u32_u24 v2, s58, v7
    v_lshl_add_u32 v2, v8, 4, v2
    v_lshlrev_b32 v3, 10, v7
    v_lshl_add_u32 v3, v9, 4, v3
    v_lshl_add_u32 v3, v10, 3, v3
    s_mov_b32 s39, 0x20000
    s_movk_i32 s42, 4096
    s_mov_b32 s43, s39
    s_waitcnt lgkmcnt(0)
    s_cselect_b64 s[36:37], s[14:15], s[28:29]
    s_cselect_b64 s[40:41], s[8:9], s[26:27]
    s_lshl2_add_u32 s51, s97, s51
    s_lshl_b32 s51, s51, 6
    s_lshl_b32 s58, s58, 2
    s_cmp_eq_u32 s63, 1
    s_cbranch_scc1 L_T_setup
    buffer_load_dwordx2 v[4:5], v3, s[40:43], s52 offen
    buffer_load_dwordx4 v[64:67], v2, s[36:39], s51 offen nt
    s_add_u32 s51, s51, s58
    buffer_load_dwordx4 v[68:71], v2, s[36:39], s51 offen nt
    s_add_u32 s51, s51, s58
    buffer_load_dwordx4 v[72:75], v2, s[36:39], s51 offen nt
    s_add_u32 s51, s51, s58
    buffer_load_dwordx4 v[76:79], v2, s[36:39], s51 offen nt
    s_add_u32 s51, s51, s58
    buffer_load_dwordx4 v[80:83], v2, s[36:39], s51 offen nt
    s_add_u32 s51, s51, s58
    buffer_load_dwordx4 v[84:87], v2, s[36:39], s51 offen nt
    s_add_u32 s51, s51, s58
    buffer_load_dwordx4 v[88:91], v2, s[36:39], s51 offen nt
    s_add_u32 s51, s51, s58
    buffer_load_dwordx4 v[92:95], v2, s[36:39], s51 offen nt
    s_add_u32 s51, s51, s58
    buffer_load_dwordx4 v[96:99], v2, s[36:39], s51 offen nt
    s_add_u32 s51, s51, s58
    buffer_load_dwordx4 v[100:103], v2, s[36:39], s51 offen nt
    s_add_u32 s51, s51, s58
    buffer_load_dwordx4 v[104:107], v2, s[36:39], s51 offen nt
    s_add_u32 s51, s51, s58
    buffer_load_dwordx4 v[108:111], v2, s[36:39], s51 offen nt
    s_add_u32 s51, s51, s58
    buffer_load_dwordx4 v[112:115], v2, s[36:39], s51 offen nt
    s_add_u32 s51, s51, s58
    buffer_load_dwordx4 v[116:119], v2, s[36:39], s51 offen nt
    s_add_u32 s51, s51, s58
    buffer_load_dwordx4 v[120:123], v2, s[36:39], s51 offen nt
    s_add_u32 s51, s51, s58
    buffer_load_dwordx4 v[124:127], v2, s[36:39], s51 offen nt
    s_cmp_lt_u32 s5, 16
    s_cbranch_scc1 L_T_setup
    v_lshlrev_b32 v11, 10, v7
    v_lshl_add_u32 v11, v8, 4, v11
    buffer_load_dwordx4 v[32:35], v11, s[40:43], 0 offen offset:0
    buffer_load_dwordx4 v[36:39], v11, s[40:43], 0 offen offset:256
    buffer_load_dwordx4 v[40:43], v11, s[40:43], 0 offen offset:512
    buffer_load_dwordx4 v[44:47], v11, s[40:43], 0 offen offset:768
    s_branch L_T_setup
L_other:
    s_cmp_lt_u32 s3, 4
    s_cbranch_scc1 L_T23_issue
    s_cmp_lt_u32 s2, 8
    s_cbranch_scc0 L_A
    s_getpc_b64 s[56:57]
L_pc:
    v_and_b32 v2, 0xff, v0
    v_lshlrev_b32 v2, 7, v2
    v_cmp_gt_u32 vcc, L_codeend-L_pc, v2
    s_and_saveexec_b64 s[60:61], vcc
    s_cbranch_execz L_pfx
    global_load_dword v63, v2, s[56:57]
L_pfx:
    s_mov_b64 exec, -1
    s_branch L_A
L_T23_issue:
    v_and_b32 v4, 31, v0
    v_lshlrev_b32 v4, 2, v4
    v_add_u32 v4, 111296, v4
    v_mov_b32 v3, 0
    ds_write_b32 v4, v3
    s_waitcnt lgkmcnt(0)
L_T_setup:
    v_and_b32 v0, 63, v0
    s_load_dword s48, s[32:33], 0
    s_mov_b32 s34, 0x10000000
    s_mov_b32 s35, 0x20000
    s_movk_i32 s49, 4095
    s_mov_b32 s96, 2097152
    v_mov_b32 v13, 111296
    v_mov_b32 v14, 1
    v_lshlrev_b32 v6, 4, v0
    s_mov_b32 s59, 0x07060302
    s_cmp_eq_u32 s4, 7
    s_cselect_b32 s99, 4, s4
    s_cmp_eq_u32 s4, 4
    s_cselect_b32 s99, 7, s99
    s_mul_i32 s63, s54, 4608
    s_add_u32 s63, s63, 65536
    v_mov_b32 v16, 0
    v_mov_b32 v17, 0
    v_mov_b32 v18, 0
    v_mov_b32 v19, 0
    v_add_u32 v20, s63, v6
    ds_write_b128 v20, v[16:19] offset:0
    ds_write_b128 v20, v[16:19] offset:1024
    ds_write_b128 v20, v[16:19] offset:2048
    ds_write_b128 v20, v[16:19] offset:3072
    s_mov_b32 exec_hi, 0
    ds_write_b128 v20, v[16:19] offset:4096
    v_add_u32 v20, 87552, v6
    ds_write_b128 v20, v[16:19]
    s_mov_b32 exec_hi, -1
    s_cmp_eq_u32 s54, 1
    s_cbranch_scc0 L_T_gate
    s_waitcnt vmcnt(16)
    s_cmp_lt_u32 s5, 16
    s_cbranch_scc0 L_T_gate
    s_waitcnt vmcnt(12)
L_T_gate:
    s_barrier
    s_getreg_b32 s18, hwreg(HW_REG_XCC_ID, 0, 3)
    s_lshl_b32 s18, s18, 9
    v_and_b32 v1, 3, v0
    v_mul_u32_u24 v1, 0x2d5, v1
    s_waitcnt lgkmcnt(0)
    s_add_u32 s48, s48, 1
    v_add_u32 v1, s48, v1
    v_add_u32 v15, s18, v1
    v_and_b32 v1, s49, v1
    v_and_b32 v15, s49, v15
    s_cmp_gt_u32 s54, 1
    s_cbranch_scc1 L_T23_job
    s_mov_b64 exec, 1
    ds_add_u32 v13, v14 offset:24
    s_mov_b64 exec, -1
    s_cmp_lt_u32 s5, 8
    s_cselect_b32 s60, s54, 0
    s_cmp_eq_u32 s60, 1
    s_cbranch_scc1 L_T1_red
    v_bfe_u32 v16, v0, 2, 1
    v_lshlrev_b32 v12, 7, v16
    v_lshl_add_u32 v12, v7, 5, v12
    v_lshl_add_u32 v12, v10, 4, v12
    v_add_u32 v12, s63, v12
    v_and_b32 v63, 3, v0
    v_mul_u32_u24 v63, 0x5555, v63
    v_lshrrev_b32 v18, 5, v0
    v_mul_u32_u24 v16, 2304, v18
    v_mul_u32_u24 v17, 288, v9
    v_add3_u32 v11, v16, v17, s63
    v_and_b32 v17, 1, v7
    v_lshl_add_u32 v11, v17, 4, v11
    v_lshl_add_u32 v11, v10, 6, v11
    v_mov_b32 v24, 0
    v_mov_b32 v25, 0
    v_mov_b32 v26, 0
    v_mov_b32 v27, 0
    v_mov_b32 v28, 0
    v_mov_b32 v29, 0
    v_mov_b32 v30, 0
    v_mov_b32 v31, 0
    v_lshlrev_b32 v2, 7, v17
    v_lshl_add_u32 v2, v9, 4, v2
    s_lshl_b32 s60, s54, 10
    s_add_u32 s61, s60, 98944
    v_add_u32 v56, s61, v6
    s_sub_u32 s61, 99968, s60
    v_add_u32 v57, s61, v6
    s_cmp_ge_u32 s5, 16
    s_cbranch_scc1 L_TQ_job
    v_lshl_add_u32 v2, v18, 11, v2
    v_lshl_add_u32 v2, v10, 13, v2
    s_lshr_b32 s61, s4, 1
    s_cmp_lt_u32 s5, 8
    s_cselect_b32 s61, s4, s61
    s_lshl_b32 s51, s97, 14
    s_lshl_b32 s60, s61, 8
    s_add_u32 s51, s51, s60
    s_lshl_b32 s60, s54, 12
    s_add_u32 s51, s51, s60
    s_add_u32 s51, s51, 65536
    s_add_u32 s52, s51, 4096
    s_mov_b32 s60, 0xbfb8aa3b
    s_waitcnt vmcnt(16)
    v_lshlrev_b32 v16, 16, v4
    v_and_b32 v17, 0xffff0000, v4
    v_lshlrev_b32 v18, 16, v5
    v_and_b32 v19, 0xffff0000, v5
    v_mul_f32 v20, s60, v16
    v_mul_f32 v21, s60, v17
    v_mul_f32 v22, s60, v18
    v_mul_f32 v23, s60, v19
    v_exp_f32 v20, v20
    v_exp_f32 v21, v21
    v_exp_f32 v22, v22
    v_exp_f32 v23, v23
    v_add_f32 v20, 1.0, v20
    v_add_f32 v21, 1.0, v21
    v_add_f32 v22, 1.0, v22
    v_add_f32 v23, 1.0, v23
    v_rcp_f32 v20, v20
    v_rcp_f32 v21, v21
    v_rcp_f32 v22, v22
    v_rcp_f32 v23, v23
    v_mul_f32 v16, v16, v20
    v_mul_f32 v17, v17, v21
    v_mul_f32 v18, v18, v22
    v_mul_f32 v19, v19, v23
    v_and_b32 v20, 0xffff0000, v16
    v_and_b32 v21, 0xffff0000, v17
    v_and_b32 v22, 0xffff0000, v18
    v_and_b32 v23, 0xffff0000, v19
    v_sub_f32 v20, v16, v20
    v_sub_f32 v21, v17, v21
    v_sub_f32 v22, v18, v22
    v_sub_f32 v23, v19, v23
    v_perm_b32 v16, v16, v20, s59
    v_perm_b32 v17, v17, v21, s59
    v_perm_b32 v18, v18, v22, s59
    v_perm_b32 v19, v19, v23, s59
    s_cmp_ge_u32 s5, 8
    s_cbranch_scc1 L_T_pair
    ds_write2_b32 v11, v16, v17 offset0:0 offset1:2
    ds_write2_b32 v11, v18, v19 offset0:8 offset1:10
    ds_write2_b32 v11, v16, v17 offset0:33 offset1:35
    ds_write2_b32 v11, v18, v19 offset0:41 offset1:43
    ds_read_b128 v[128:131], v12 offset:0
    ds_read_b128 v[160:163], v12 offset:2304
    ds_read_b128 v[132:135], v12 offset:288
    ds_read_b128 v[164:167], v12 offset:2592
    ds_read_b128 v[136:139], v12 offset:576
    ds_read_b128 v[168:171], v12 offset:2880
    ds_read_b128 v[140:143], v12 offset:864
    ds_read_b128 v[172:175], v12 offset:3168
    ds_read_b128 v[144:147], v12 offset:1152
    ds_read_b128 v[176:179], v12 offset:3456
    ds_read_b128 v[148:151], v12 offset:1440
    ds_read_b128 v[180:183], v12 offset:3744
    ds_read_b128 v[152:155], v12 offset:1728
    ds_read_b128 v[184:187], v12 offset:4032
    ds_read_b128 v[156:159], v12 offset:2016
    ds_read_b128 v[188:191], v12 offset:4320
    s_waitcnt vmcnt(14) lgkmcnt(14)
    v_smfmac_f32_16x16x64_bf16 v[24:27], v[128:131], v[64:71], v63
    v_smfmac_f32_16x16x64_bf16 v[28:31], v[160:163], v[64:71], v63
    s_waitcnt vmcnt(12) lgkmcnt(12)
    v_smfmac_f32_16x16x64_bf16 v[24:27], v[132:135], v[72:79], v63
    v_smfmac_f32_16x16x64_bf16 v[28:31], v[164:167], v[72:79], v63
    s_waitcnt vmcnt(10) lgkmcnt(10)
    v_smfmac_f32_16x16x64_bf16 v[24:27], v[136:139], v[80:87], v63
    v_smfmac_f32_16x16x64_bf16 v[28:31], v[168:171], v[80:87], v63
    s_waitcnt vmcnt(8) lgkmcnt(8)
    v_smfmac_f32_16x16x64_bf16 v[24:27], v[140:143], v[88:95], v63
    v_smfmac_f32_16x16x64_bf16 v[28:31], v[172:175], v[88:95], v63
    s_waitcnt vmcnt(6) lgkmcnt(6)
    v_smfmac_f32_16x16x64_bf16 v[24:27], v[144:147], v[96:103], v63
    v_smfmac_f32_16x16x64_bf16 v[28:31], v[176:179], v[96:103], v63
    s_waitcnt vmcnt(4) lgkmcnt(4)
    v_smfmac_f32_16x16x64_bf16 v[24:27], v[148:151], v[104:111], v63
    v_smfmac_f32_16x16x64_bf16 v[28:31], v[180:183], v[104:111], v63
    s_waitcnt vmcnt(2) lgkmcnt(2)
    v_smfmac_f32_16x16x64_bf16 v[24:27], v[152:155], v[112:119], v63
    v_smfmac_f32_16x16x64_bf16 v[28:31], v[184:187], v[112:119], v63
    s_waitcnt vmcnt(0) lgkmcnt(0)
    v_smfmac_f32_16x16x64_bf16 v[24:27], v[156:159], v[120:127], v63
    v_smfmac_f32_16x16x64_bf16 v[28:31], v[188:191], v[120:127], v63
    s_nop 6
    v_bfi_b32 v24, s49, v1, v24
    v_bfi_b32 v28, s49, v1, v28
    buffer_store_dwordx4 v[24:27], v2, s[32:35], s51 offen sc1
    buffer_store_dwordx4 v[28:31], v2, s[32:35], s52 offen sc1
    s_mov_b64 exec, 1
    ds_add_u32 v13, v14 offset:20
    s_mov_b64 exec, -1
    s_branch L_T_k
L_T1_red:
    s_and_b32 s62, s7, 1
    s_lshl_b32 s61, s62, 3
    s_add_u32 s61, s61, s4
    s_lshl_b32 s51, s61, 14
    s_lshl_b32 s60, s6, 11
    s_add_u32 s51, s51, s60
    s_add_u32 s51, s51, 196608
    s_add_u32 s52, s51, 8192
    s_lshl_b32 s56, s6, 13
    s_lshl_b32 s60, s61, 9
    s_add_u32 s56, s56, s60
    s_add_u32 s56, s56, 458752
    v_lshlrev_b32 v3, 4, v8
    v_lshl_add_u32 v3, v7, 2, v3
    v_add_u32 v3, 98944, v3
    v_add_u32 v4, 98944, v6
L_spin_1:
    ds_read_b32 v16, v13 offset:28
    s_sub_u32 s96, s96, 1
    s_cbranch_scc1 L_end
    s_waitcnt lgkmcnt(0)
    v_cmp_gt_u32 vcc, 2, v16
    s_cbranch_vccnz L_spin_2
L_poll_4:
    buffer_load_dwordx4 v[64:67], v6, s[32:35], s51 offen sc1
    buffer_load_dwordx4 v[68:71], v6, s[32:35], s52 offen sc1
    s_sub_u32 s96, s96, 1
    s_cbranch_scc1 L_end
L_chk_3:
    s_waitcnt vmcnt(0)
    v_xor_b32 v64, v64, v1
    v_xor_b32 v68, v68, v1
    v_or_b32 v16, v64, v68
    v_and_b32 v16, s49, v16
    v_cmp_ne_u32 vcc, 0, v16
    s_cbranch_vccnz L_poll_4
    v_permlane32_swap_b32 v64, v66
    v_permlane32_swap_b32 v65, v67
    v_permlane32_swap_b32 v68, v70
    v_permlane32_swap_b32 v69, v71
    v_pk_add_f32 v[64:65], v[64:65], v[66:67]
    v_pk_add_f32 v[68:69], v[68:69], v[70:71]
    s_nop 0
    v_permlane16_swap_b32 v64, v65
    v_permlane16_swap_b32 v68, v69
    v_add_f32 v16, v64, v65
    v_add_f32 v17, v68, v69
    ds_write2_b32 v3, v16, v17 offset0:0 offset1:64
    s_mov_b32 exec_hi, 0
    ds_read_b128 v[20:23], v4
    s_waitcnt lgkmcnt(0)
    v_bfi_b32 v20, s49, v1, v20
    buffer_store_dwordx4 v[20:23], v6, s[32:35], s56 offen sc1
    s_mov_b32 exec_hi, -1
L_T_k:
    s_lshl_b32 s61, s54, 14
    v_and_b32 v17, 3, v0
    v_lshrrev_b32 v18, 2, v8
    v_lshl_add_u32 v19, v17, 2, v18
    v_xor_b32 v16, v7, v8
    v_lshlrev_b32 v48, 4, v16
    v_lshl_add_u32 v48, v19, 8, v48
    v_add_u32 v48, s61, v48
    v_xor_b32 v49, 64, v48
    v_xor_b32 v50, 0x80, v48
    v_xor_b32 v51, 0xc0, v48
    v_mul_u32_u24 v52, 320, v17
    v_lshl_add_u32 v52, v7, 4, v52
    v_add_u32 v52, 83968, v52
    s_lshl_b32 s61, s54, 2
    v_add_u32 v53, s61, v13
    s_add_u32 s61, s61, 96832
    v_add_u32 v62, s61, v6
    s_lshl_b32 s61, s54, 9
    s_add_u32 s61, s61, 85504
    v_and_b32 v18, 1, v18
    v_lshlrev_b32 v54, 3, v18
    v_lshl_add_u32 v54, v17, 4, v54
    v_lshl_add_u32 v54, v7, 6, v54
    v_lshl_add_u32 v54, v10, 8, v54
    v_add_u32 v54, s61, v54
    s_mul_i32 s61, s54, 544
    s_add_u32 s61, s61, 88064
    v_add_u32 v55, s61, v6
    s_lshl_b32 s19, s4, 5
    s_lshl3_add_u32 s19, s6, s19
    s_add_u32 s19, s19, s7
    s_mul_i32 s19, s19, 1152
    s_add_u32 s19, s19, 1048576
L_T_k2:
    s_cmp_ge_u32 s5, 16
    s_cbranch_scc1 L_fp_5
    s_cmp_eq_u32 s99, 7
    s_cbranch_scc1 L_fp_5
    s_mov_b64 s[36:37], s[20:21]
    s_mov_b32 s38, 1835008
    s_mov_b32 s39, 0x20000
    s_mov_b64 s[40:41], s[22:23]
    s_mov_b32 s42, 1835008
    s_mov_b32 s43, 0x20000
    s_lshl_b32 s61, s99, 2
    s_add_u32 s61, s61, s7
    s_mul_i32 s97, s54, 458752
    s_lshl_b32 s60, s61, 7
    s_add_u32 s97, s97, s60
    s_lshl_b32 s58, s6, 0
    v_lshrrev_b32 v12, 3, v0
    v_mul_u32_u24 v12, 3584, v12
    v_lshl_add_u32 v12, v9, 4, v12
    s_mov_b64 s[44:45], s[8:9]
    s_mov_b32 s46, 4096
    s_mov_b32 s47, 0x20000
    v_lshlrev_b32 v21, 4, v9
    v_lshl_add_u32 v21, v10, 3, v21
    v_lshl_add_u32 v21, v7, 1, v21
    s_lshl_b32 s62, s6, 10
    s_lshl_b32 s60, s54, 8
    s_add_u32 s62, s62, s60
L_spin_6:
    ds_read_b32 v16, v13 offset:100
    s_sub_u32 s96, s96, 1
    s_cbranch_scc1 L_end
    s_waitcnt lgkmcnt(0)
    v_cmp_gt_u32 vcc, 2, v16
    s_cbranch_vccnz L_spin_7
    buffer_load_ushort v22, v21, s[44:47], s62 offen
    buffer_load_ushort v23, v21, s[44:47], s62 offen offset:128
L_fp_5:
L_spin_8:
    ds_read_b32 v16, v53 offset:64
    s_sub_u32 s96, s96, 1
    s_cbranch_scc1 L_end
    s_waitcnt lgkmcnt(0)
    v_cmp_gt_u32 vcc, 1, v16
    s_cbranch_vccnz L_spin_8
    ds_read_b128 v[128:131], v48 offset:0
    ds_read_b128 v[132:135], v49 offset:0
    ds_read_b128 v[136:139], v50 offset:0
    ds_read_b128 v[140:143], v51 offset:0
    ds_read_b128 v[144:147], v48 offset:4096
    ds_read_b128 v[148:151], v49 offset:4096
    ds_read_b128 v[152:155], v50 offset:4096
    ds_read_b128 v[156:159], v51 offset:4096
    ds_read_b128 v[160:163], v48 offset:8192
    ds_read_b128 v[164:167], v49 offset:8192
    ds_read_b128 v[168:171], v50 offset:8192
    ds_read_b128 v[172:175], v51 offset:8192
    ds_read_b128 v[176:179], v48 offset:12288
    ds_read_b128 v[180:183], v49 offset:12288
    ds_read_b128 v[184:187], v50 offset:12288
    ds_read_b128 v[188:191], v51 offset:12288
    s_branch L_T_qk
L_TQ_job:
    v_lshl_add_u32 v2, v18, 13, v2
    v_lshl_add_u32 v2, v10, 8, v2
    s_lshl_b32 s51, s4, 15
    s_lshl_b32 s60, s5, 9
    s_add_u32 s51, s51, s60
    s_add_u32 s51, s51, 516096
    s_lshl_b32 s60, s54, 14
    s_add_u32 s51, s51, s60
    s_waitcnt vmcnt(0)
    v_lshlrev_b32 v128, 16, v32
    v_and_b32 v129, 0xffff0000, v32
    v_lshlrev_b32 v130, 16, v33
    v_and_b32 v131, 0xffff0000, v33
    v_lshlrev_b32 v132, 16, v34
    v_and_b32 v133, 0xffff0000, v34
    v_lshlrev_b32 v134, 16, v35
    v_and_b32 v135, 0xffff0000, v35
    v_lshlrev_b32 v136, 16, v36
    v_and_b32 v137, 0xffff0000, v36
    v_lshlrev_b32 v138, 16, v37
    v_and_b32 v139, 0xffff0000, v37
    v_lshlrev_b32 v140, 16, v38
    v_and_b32 v141, 0xffff0000, v38
    v_lshlrev_b32 v142, 16, v39
    v_and_b32 v143, 0xffff0000, v39
    v_lshlrev_b32 v144, 16, v40
    v_and_b32 v145, 0xffff0000, v40
    v_lshlrev_b32 v146, 16, v41
    v_and_b32 v147, 0xffff0000, v41
    v_lshlrev_b32 v148, 16, v42
    v_and_b32 v149, 0xffff0000, v42
    v_lshlrev_b32 v150, 16, v43
    v_and_b32 v151, 0xffff0000, v43
    v_lshlrev_b32 v152, 16, v44
    v_and_b32 v153, 0xffff0000, v44
    v_lshlrev_b32 v154, 16, v45
    v_and_b32 v155, 0xffff0000, v45
    v_lshlrev_b32 v156, 16, v46
    v_and_b32 v157, 0xffff0000, v46
    v_lshlrev_b32 v158, 16, v47
    v_and_b32 v159, 0xffff0000, v47
    v_pk_add_f32 v[16:17], v[128:129], v[130:131]
    v_pk_add_f32 v[16:17], v[16:17], v[132:133]
    v_pk_add_f32 v[16:17], v[16:17], v[134:135]
    v_pk_add_f32 v[16:17], v[16:17], v[136:137]
    v_pk_add_f32 v[16:17], v[16:17], v[138:139]
    v_pk_add_f32 v[16:17], v[16:17], v[140:141]
    v_pk_add_f32 v[16:17], v[16:17], v[142:143]
    v_pk_add_f32 v[16:17], v[16:17], v[144:145]
    v_pk_add_f32 v[16:17], v[16:17], v[146:147]
    v_pk_add_f32 v[16:17], v[16:17], v[148:149]
    v_pk_add_f32 v[16:17], v[16:17], v[150:151]
    v_pk_add_f32 v[16:17], v[16:17], v[152:153]
    v_pk_add_f32 v[16:17], v[16:17], v[154:155]
    v_pk_add_f32 v[16:17], v[16:17], v[156:157]
    v_pk_add_f32 v[16:17], v[16:17], v[158:159]
    v_add_f32 v16, v16, v17
    s_nop 1
    v_add_f32_dpp v16, v16, v16 row_ror:1 row_mask:0xf bank_mask:0xf
    s_nop 1
    v_add_f32_dpp v16, v16, v16 row_ror:2 row_mask:0xf bank_mask:0xf
    s_nop 1
    v_add_f32_dpp v16, v16, v16 row_ror:4 row_mask:0xf bank_mask:0xf
    s_nop 1
    v_add_f32_dpp v16, v16, v16 row_ror:8 row_mask:0xf bank_mask:0xf
    v_mul_f32 v16, 0xbb000000, v16
    v_mov_b32 v17, v16
    v_mov_b32 v18, 0
    v_mov_b32 v19, 0
    v_pk_add_f32 v[128:129], v[128:129], v[16:17]
    v_pk_fma_f32 v[18:19], v[128:129], v[128:129], v[18:19]
    v_pk_add_f32 v[130:131], v[130:131], v[16:17]
    v_pk_fma_f32 v[18:19], v[130:131], v[130:131], v[18:19]
    v_pk_add_f32 v[132:133], v[132:133], v[16:17]
    v_pk_fma_f32 v[18:19], v[132:133], v[132:133], v[18:19]
    v_pk_add_f32 v[134:135], v[134:135], v[16:17]
    v_pk_fma_f32 v[18:19], v[134:135], v[134:135], v[18:19]
    v_pk_add_f32 v[136:137], v[136:137], v[16:17]
    v_pk_fma_f32 v[18:19], v[136:137], v[136:137], v[18:19]
    v_pk_add_f32 v[138:139], v[138:139], v[16:17]
    v_pk_fma_f32 v[18:19], v[138:139], v[138:139], v[18:19]
    v_pk_add_f32 v[140:141], v[140:141], v[16:17]
    v_pk_fma_f32 v[18:19], v[140:141], v[140:141], v[18:19]
    v_pk_add_f32 v[142:143], v[142:143], v[16:17]
    v_pk_fma_f32 v[18:19], v[142:143], v[142:143], v[18:19]
    v_pk_add_f32 v[144:145], v[144:145], v[16:17]
    v_pk_fma_f32 v[18:19], v[144:145], v[144:145], v[18:19]
    v_pk_add_f32 v[146:147], v[146:147], v[16:17]
    v_pk_fma_f32 v[18:19], v[146:147], v[146:147], v[18:19]
    v_pk_add_f32 v[148:149], v[148:149], v[16:17]
    v_pk_fma_f32 v[18:19], v[148:149], v[148:149], v[18:19]
    v_pk_add_f32 v[150:151], v[150:151], v[16:17]
    v_pk_fma_f32 v[18:19], v[150:151], v[150:151], v[18:19]
    v_pk_add_f32 v[152:153], v[152:153], v[16:17]
    v_pk_fma_f32 v[18:19], v[152:153], v[152:153], v[18:19]
    v_pk_add_f32 v[154:155], v[154:155], v[16:17]
    v_pk_fma_f32 v[18:19], v[154:155], v[154:155], v[18:19]
    v_pk_add_f32 v[156:157], v[156:157], v[16:17]
    v_pk_fma_f32 v[18:19], v[156:157], v[156:157], v[18:19]
    v_pk_add_f32 v[158:159], v[158:159], v[16:17]
    v_pk_fma_f32 v[18:19], v[158:159], v[158:159], v[18:19]
    v_add_f32 v18, v18, v19
    s_nop 1
    v_add_f32_dpp v18, v18, v18 row_ror:1 row_mask:0xf bank_mask:0xf
    s_nop 1
    v_add_f32_dpp v18, v18, v18 row_ror:2 row_mask:0xf bank_mask:0xf
    s_nop 1
    v_add_f32_dpp v18, v18, v18 row_ror:4 row_mask:0xf bank_mask:0xf
    s_nop 1
    v_add_f32_dpp v18, v18, v18 row_ror:8 row_mask:0xf bank_mask:0xf
    v_mov_b32 v19, 0x3727c5ac
    v_fmac_f32 v19, 0x3b000000, v18
    v_rsq_f32 v19, v19
    v_lshlrev_b32 v20, 16, v4
    v_and_b32 v21, 0xffff0000, v4
    v_lshlrev_b32 v22, 16, v5
    v_and_b32 v23, 0xffff0000, v5
    v_add_f32 v20, v20, v16
    v_add_f32 v21, v21, v16
    v_add_f32 v22, v22, v16
    v_add_f32 v23, v23, v16
    v_mul_f32 v20, v20, v19
    v_mul_f32 v21, v21, v19
    v_mul_f32 v22, v22, v19
    v_mul_f32 v23, v23, v19
    v_lshlrev_b32 v3, 11, v7
    v_lshl_add_u32 v3, v8, 4, v3
    s_lshl_b32 s61, s98, 13
    s_add_u32 s61, s61, 65536
    s_add_u32 s62, s61, 65536
L_spin_9:
    ds_read_b32 v16, v13 offset:28
    s_sub_u32 s96, s96, 1
    s_cbranch_scc1 L_end
    s_waitcnt lgkmcnt(0)
    v_cmp_gt_u32 vcc, 4, v16
    s_cbranch_vccnz L_spin_9
    buffer_load_dwordx4 v[128:131], v3, s[32:35], s61 offen offset:0 sc1
    buffer_load_dwordx4 v[132:135], v3, s[32:35], s61 offen offset:256 sc1
    buffer_load_dwordx4 v[136:139], v3, s[32:35], s61 offen offset:512 sc1
    buffer_load_dwordx4 v[140:143], v3, s[32:35], s61 offen offset:768 sc1
    buffer_load_dwordx4 v[144:147], v3, s[32:35], s61 offen offset:1024 sc1
    buffer_load_dwordx4 v[148:151], v3, s[32:35], s61 offen offset:1280 sc1
    buffer_load_dwordx4 v[152:155], v3, s[32:35], s61 offen offset:1536 sc1
    buffer_load_dwordx4 v[156:159], v3, s[32:35], s61 offen offset:1792 sc1
    buffer_load_dwordx4 v[160:163], v3, s[32:35], s62 offen offset:0 sc1
    buffer_load_dwordx4 v[164:167], v3, s[32:35], s62 offen offset:256 sc1
    buffer_load_dwordx4 v[168:171], v3, s[32:35], s62 offen offset:512 sc1
    buffer_load_dwordx4 v[172:175], v3, s[32:35], s62 offen offset:768 sc1
    buffer_load_dwordx4 v[176:179], v3, s[32:35], s62 offen offset:1024 sc1
    buffer_load_dwordx4 v[180:183], v3, s[32:35], s62 offen offset:1280 sc1
    buffer_load_dwordx4 v[184:187], v3, s[32:35], s62 offen offset:1536 sc1
    buffer_load_dwordx4 v[188:191], v3, s[32:35], s62 offen offset:1792 sc1
    s_mov_b64 exec, 1
    ds_add_u32 v13, v14 offset:32
    s_mov_b64 exec, -1
L_spin_12:
    ds_read_b32 v16, v13 offset:24
    s_sub_u32 s96, s96, 1
    s_cbranch_scc1 L_end
    s_waitcnt lgkmcnt(0)
    v_cmp_gt_u32 vcc, 8, v16
    s_cbranch_vccnz L_spin_12
    s_branch L_chk_10
L_poll_11:
    buffer_load_dwordx4 v[128:131], v3, s[32:35], s61 offen offset:0 sc1
    buffer_load_dwordx4 v[132:135], v3, s[32:35], s61 offen offset:256 sc1
    buffer_load_dwordx4 v[136:139], v3, s[32:35], s61 offen offset:512 sc1
    buffer_load_dwordx4 v[140:143], v3, s[32:35], s61 offen offset:768 sc1
    buffer_load_dwordx4 v[144:147], v3, s[32:35], s61 offen offset:1024 sc1
    buffer_load_dwordx4 v[148:151], v3, s[32:35], s61 offen offset:1280 sc1
    buffer_load_dwordx4 v[152:155], v3, s[32:35], s61 offen offset:1536 sc1
    buffer_load_dwordx4 v[156:159], v3, s[32:35], s61 offen offset:1792 sc1
    buffer_load_dwordx4 v[160:163], v3, s[32:35], s62 offen offset:0 sc1
    buffer_load_dwordx4 v[164:167], v3, s[32:35], s62 offen offset:256 sc1
    buffer_load_dwordx4 v[168:171], v3, s[32:35], s62 offen offset:512 sc1
    buffer_load_dwordx4 v[172:175], v3, s[32:35], s62 offen offset:768 sc1
    buffer_load_dwordx4 v[176:179], v3, s[32:35], s62 offen offset:1024 sc1
    buffer_load_dwordx4 v[180:183], v3, s[32:35], s62 offen offset:1280 sc1
    buffer_load_dwordx4 v[184:187], v3, s[32:35], s62 offen offset:1536 sc1
    buffer_load_dwordx4 v[188:191], v3, s[32:35], s62 offen offset:1792 sc1
    s_sub_u32 s96, s96, 1
    s_cbranch_scc1 L_end
L_chk_10:
    s_waitcnt vmcnt(0)
    v_xor_b32 v128, v128, v1
    v_xor_b32 v132, v132, v1
    v_xor_b32 v136, v136, v1
    v_xor_b32 v140, v140, v1
    v_xor_b32 v144, v144, v1
    v_xor_b32 v148, v148, v1
    v_xor_b32 v152, v152, v1
    v_xor_b32 v156, v156, v1
    v_xor_b32 v160, v160, v1
    v_xor_b32 v164, v164, v1
    v_xor_b32 v168, v168, v1
    v_xor_b32 v172, v172, v1
    v_xor_b32 v176, v176, v1
    v_xor_b32 v180, v180, v1
    v_xor_b32 v184, v184, v1
    v_xor_b32 v188, v188, v1
    v_or_b32 v16, v128, v132
    v_or3_b32 v16, v16, v136, v140
    v_or3_b32 v16, v16, v144, v148
    v_or3_b32 v16, v16, v152, v156
    v_or3_b32 v16, v16, v160, v164
    v_or3_b32 v16, v16, v168, v172
    v_or3_b32 v16, v16, v176, v180
    v_or3_b32 v16, v16, v184, v188
    v_and_b32 v16, s49, v16
    v_cmp_ne_u32 vcc, 0, v16
    s_cbranch_vccnz L_poll_11
    v_pk_add_f32 v[128:129], v[128:129], v[132:133]
    v_pk_add_f32 v[130:131], v[130:131], v[134:135]
    v_pk_add_f32 v[136:137], v[136:137], v[140:141]
    v_pk_add_f32 v[138:139], v[138:139], v[142:143]
    v_pk_add_f32 v[144:145], v[144:145], v[148:149]
    v_pk_add_f32 v[146:147], v[146:147], v[150:151]
    v_pk_add_f32 v[152:153], v[152:153], v[156:157]
    v_pk_add_f32 v[154:155], v[154:155], v[158:159]
    v_pk_add_f32 v[128:129], v[128:129], v[136:137]
    v_pk_add_f32 v[130:131], v[130:131], v[138:139]
    v_pk_add_f32 v[144:145], v[144:145], v[152:153]
    v_pk_add_f32 v[146:147], v[146:147], v[154:155]
    v_pk_add_f32 v[128:129], v[128:129], v[144:145]
    v_pk_add_f32 v[130:131], v[130:131], v[146:147]
    v_pk_add_f32 v[160:161], v[160:161], v[164:165]
    v_pk_add_f32 v[162:163], v[162:163], v[166:167]
    v_pk_add_f32 v[168:169], v[168:169], v[172:173]
    v_pk_add_f32 v[170:171], v[170:171], v[174:175]
    v_pk_add_f32 v[176:177], v[176:177], v[180:181]
    v_pk_add_f32 v[178:179], v[178:179], v[182:183]
    v_pk_add_f32 v[184:185], v[184:185], v[188:189]
    v_pk_add_f32 v[186:187], v[186:187], v[190:191]
    v_pk_add_f32 v[160:161], v[160:161], v[168:169]
    v_pk_add_f32 v[162:163], v[162:163], v[170:171]
    v_pk_add_f32 v[176:177], v[176:177], v[184:185]
    v_pk_add_f32 v[178:179], v[178:179], v[186:187]
    v_pk_add_f32 v[160:161], v[160:161], v[176:177]
    v_pk_add_f32 v[162:163], v[162:163], v[178:179]
    v_pk_add_f32 v[128:129], v[128:129], v[20:21]
    v_pk_add_f32 v[130:131], v[130:131], v[22:23]
    v_pk_fma_f32 v[128:129], v[160:161], v[20:21], v[128:129]
    v_pk_fma_f32 v[130:131], v[162:163], v[22:23], v[130:131]
    v_and_b32 v16, 0xffff0000, v128
    v_and_b32 v17, 0xffff0000, v129
    v_and_b32 v18, 0xffff0000, v130
    v_and_b32 v19, 0xffff0000, v131
    v_sub_f32 v16, v128, v16
    v_sub_f32 v17, v129, v17
    v_sub_f32 v18, v130, v18
    v_sub_f32 v19, v131, v19
    v_perm_b32 v16, v128, v16, s59
    v_perm_b32 v17, v129, v17, s59
    v_perm_b32 v18, v130, v18, s59
    v_perm_b32 v19, v131, v19, s59
L_T_pair:
    ds_write2_b32 v11, v16, v17 offset0:0 offset1:2
    ds_write2_b32 v11, v18, v19 offset0:8 offset1:10
    ds_write2_b32 v11, v16, v17 offset0:33 offset1:35
    ds_write2_b32 v11, v18, v19 offset0:41 offset1:43
    s_xor_b32 s60, s54, 1
    s_mul_i32 s60, s60, 2304
    v_add_u32 v3, s60, v12
    s_mul_i32 s60, s54, 2304
    v_add_u32 v4, s60, v12
    ds_read_b128 v[128:131], v3 offset:0
    ds_read_b128 v[132:135], v3 offset:288
    ds_read_b128 v[136:139], v3 offset:576
    ds_read_b128 v[140:143], v3 offset:864
    ds_read_b128 v[144:147], v3 offset:1152
    ds_read_b128 v[148:151], v3 offset:1440
    ds_read_b128 v[152:155], v3 offset:1728
    ds_read_b128 v[156:159], v3 offset:2016
    ds_read_b128 v[160:163], v4 offset:0
    ds_read_b128 v[164:167], v4 offset:288
    ds_read_b128 v[168:171], v4 offset:576
    ds_read_b128 v[172:175], v4 offset:864
    ds_read_b128 v[176:179], v4 offset:1152
    ds_read_b128 v[180:183], v4 offset:1440
    ds_read_b128 v[184:187], v4 offset:1728
    ds_read_b128 v[188:191], v4 offset:2016
    s_waitcnt vmcnt(0)
    s_waitcnt lgkmcnt(15)
    v_smfmac_f32_16x16x64_bf16 v[24:27], v[128:131], v[64:71], v63
    s_waitcnt lgkmcnt(14)
    v_smfmac_f32_16x16x64_bf16 v[24:27], v[132:135], v[72:79], v63
    s_waitcnt lgkmcnt(13)
    v_smfmac_f32_16x16x64_bf16 v[24:27], v[136:139], v[80:87], v63
    s_waitcnt lgkmcnt(12)
    v_smfmac_f32_16x16x64_bf16 v[24:27], v[140:143], v[88:95], v63
    s_waitcnt lgkmcnt(11)
    v_smfmac_f32_16x16x64_bf16 v[24:27], v[144:147], v[96:103], v63
    s_waitcnt lgkmcnt(10)
    v_smfmac_f32_16x16x64_bf16 v[24:27], v[148:151], v[104:111], v63
    s_waitcnt lgkmcnt(9)
    v_smfmac_f32_16x16x64_bf16 v[24:27], v[152:155], v[112:119], v63
    s_waitcnt lgkmcnt(8)
    v_smfmac_f32_16x16x64_bf16 v[24:27], v[156:159], v[120:127], v63
    s_waitcnt lgkmcnt(7)
    v_smfmac_f32_16x16x64_bf16 v[28:31], v[160:163], v[64:71], v63
    s_waitcnt lgkmcnt(6)
    v_smfmac_f32_16x16x64_bf16 v[28:31], v[164:167], v[72:79], v63
    s_waitcnt lgkmcnt(5)
    v_smfmac_f32_16x16x64_bf16 v[28:31], v[168:171], v[80:87], v63
    s_waitcnt lgkmcnt(0)
    v_smfmac_f32_16x16x64_bf16 v[28:31], v[172:175], v[88:95], v63
    ds_write_b128 v57, v[24:27]
    s_mov_b64 exec, 1
    ds_add_u32 v13, v14 offset:40
    s_mov_b64 exec, -1
    v_smfmac_f32_16x16x64_bf16 v[28:31], v[176:179], v[96:103], v63
    v_smfmac_f32_16x16x64_bf16 v[28:31], v[180:183], v[104:111], v63
    v_smfmac_f32_16x16x64_bf16 v[28:31], v[184:187], v[112:119], v63
    v_smfmac_f32_16x16x64_bf16 v[28:31], v[188:191], v[120:127], v63
L_spin_13:
    ds_read_b32 v16, v13 offset:40
    ds_read_b128 v[20:23], v56
    s_sub_u32 s96, s96, 1
    s_cbranch_scc1 L_end
    s_waitcnt lgkmcnt(0)
    v_cmp_gt_u32 vcc, 2, v16
    s_cbranch_vccnz L_spin_13
    s_nop 0
    v_pk_add_f32 v[28:29], v[28:29], v[20:21]
    v_pk_add_f32 v[30:31], v[30:31], v[22:23]
    s_cmp_lt_u32 s5, 16
    s_cbranch_scc1 L_T_late
    v_bfi_b32 v28, s49, v15, v28
    buffer_store_dwordx4 v[28:31], v2, s[32:35], s51 offen
    s_mov_b64 exec, 1
    ds_add_u32 v13, v14 offset:12
    s_mov_b64 exec, -1
    s_lshl_b32 s61, s54, 14
    v_and_b32 v17, 3, v0
    v_lshrrev_b32 v18, 2, v8
    v_lshl_add_u32 v19, v17, 2, v18
    v_xor_b32 v16, v7, v8
    v_lshlrev_b32 v48, 4, v16
    v_lshl_add_u32 v48, v19, 8, v48
    v_add_u32 v48, s61, v48
    v_xor_b32 v49, 64, v48
    v_xor_b32 v50, 0x80, v48
    v_xor_b32 v51, 0xc0, v48
    v_mul_u32_u24 v52, 320, v17
    v_lshl_add_u32 v52, v7, 4, v52
    v_add_u32 v52, 83968, v52
    s_lshl_b32 s61, s54, 2
    v_add_u32 v53, s61, v13
    s_add_u32 s61, s61, 96832
    v_add_u32 v62, s61, v6
    s_lshl_b32 s61, s54, 9
    s_add_u32 s61, s61, 85504
    v_and_b32 v18, 1, v18
    v_lshlrev_b32 v54, 3, v18
    v_lshl_add_u32 v54, v17, 4, v54
    v_lshl_add_u32 v54, v7, 6, v54
    v_lshl_add_u32 v54, v10, 8, v54
    v_add_u32 v54, s61, v54
    s_mul_i32 s61, s54, 544
    s_add_u32 s61, s61, 88064
    v_add_u32 v55, s61, v6
    s_lshl_b32 s19, s4, 5
    s_lshl3_add_u32 s19, s6, s19
    s_add_u32 s19, s19, s7
    s_mul_i32 s19, s19, 1152
    s_add_u32 s19, s19, 1048576
L_spin_14:
    ds_read_b32 v16, v53 offset:64
    s_sub_u32 s96, s96, 1
    s_cbranch_scc1 L_end
    s_waitcnt lgkmcnt(0)
    v_cmp_gt_u32 vcc, 1, v16
    s_cbranch_vccnz L_spin_14
    ds_read_b128 v[128:131], v48 offset:0
    ds_read_b128 v[132:135], v49 offset:0
    ds_read_b128 v[136:139], v50 offset:0
    ds_read_b128 v[140:143], v51 offset:0
    ds_read_b128 v[144:147], v48 offset:4096
    ds_read_b128 v[148:151], v49 offset:4096
    ds_read_b128 v[152:155], v50 offset:4096
    ds_read_b128 v[156:159], v51 offset:4096
    ds_read_b128 v[160:163], v48 offset:8192
    ds_read_b128 v[164:167], v49 offset:8192
    ds_read_b128 v[168:171], v50 offset:8192
    ds_read_b128 v[172:175], v51 offset:8192
    ds_read_b128 v[176:179], v48 offset:12288
    ds_read_b128 v[180:183], v49 offset:12288
    ds_read_b128 v[184:187], v50 offset:12288
    ds_read_b128 v[188:191], v51 offset:12288
L_qs:
    ds_read_b64 v[16:17], v13 offset:0
    s_sub_u32 s96, s96, 1
    s_cbranch_scc1 L_end
    s_waitcnt lgkmcnt(0)
    v_or_b32 v18, v16, v17
    v_readfirstlane_b32 s55, v17
    v_cmp_eq_u32 vcc, 0, v18
    s_cbranch_vccnz L_qs
    s_cmp_eq_u32 s55, 0
    s_cbranch_scc1 L_T_qk2
    s_cmp_lg_u32 s55, 0
    s_cbranch_scc1 L_dup_15
L_dupb_16:
    s_branch L_T_qk
L_T23_job:
    s_lshl_b32 s61, s54, 14
    v_and_b32 v17, 3, v0
    v_lshrrev_b32 v18, 2, v8
    v_lshl_add_u32 v19, v17, 2, v18
    v_xor_b32 v16, v7, v8
    v_lshlrev_b32 v48, 4, v16
    v_lshl_add_u32 v48, v19, 8, v48
    v_add_u32 v48, s61, v48
    v_xor_b32 v49, 64, v48
    v_xor_b32 v50, 0x80, v48
    v_xor_b32 v51, 0xc0, v48
    v_mul_u32_u24 v52, 320, v17
    v_lshl_add_u32 v52, v7, 4, v52
    v_add_u32 v52, 83968, v52
    s_lshl_b32 s61, s54, 2
    v_add_u32 v53, s61, v13
    s_add_u32 s61, s61, 96832
    v_add_u32 v62, s61, v6
    s_lshl_b32 s61, s54, 9
    s_add_u32 s61, s61, 85504
    v_and_b32 v18, 1, v18
    v_lshlrev_b32 v54, 3, v18
    v_lshl_add_u32 v54, v17, 4, v54
    v_lshl_add_u32 v54, v7, 6, v54
    v_lshl_add_u32 v54, v10, 8, v54
    v_add_u32 v54, s61, v54
    s_mul_i32 s61, s54, 544
    s_add_u32 s61, s61, 88064
    v_add_u32 v55, s61, v6
    s_lshl_b32 s19, s4, 5
    s_lshl3_add_u32 s19, s6, s19
    s_add_u32 s19, s19, s7
    s_mul_i32 s19, s19, 1152
    s_add_u32 s19, s19, 1048576
    s_cmp_eq_u32 s54, 2
    s_cbranch_scc1 L_T2_pre
    s_mov_b64 exec, 1
    ds_add_u32 v13, v14 offset:24
    s_mov_b64 exec, -1
    s_cmp_lt_u32 s5, 16
    s_cbranch_scc1 L_T_k2
    s_lshl_b32 s51, s4, 15
    s_lshl_b32 s60, s5, 9
    s_add_u32 s51, s51, s60
    s_add_u32 s51, s51, 516096
    v_lshlrev_b32 v2, 7, v17
    v_lshl_add_u32 v2, v7, 13, v2
    buffer_load_dword v97, v2, s[32:35], s51 offen
    s_and_b32 s61, s5, 1
    s_bfe_u32 s62, s5, 0x30001
    s_lshl_b32 s51, s61, 15
    s_lshl_b32 s60, s62, 11
    s_add_u32 s51, s51, s60
    s_lshl_b32 s60, s4, 8
    s_add_u32 s51, s51, s60
    s_add_u32 s51, s51, 2097152
    v_lshrrev_b32 v3, 5, v0
    v_and_b32 v4, 1, v7
    v_lshlrev_b32 v2, 14, v3
    v_lshl_add_u32 v2, v10, 7, v2
    v_lshl_add_u32 v2, v4, 16, v2
    buffer_load_dword v97, v2, s[32:35], s51 offen
    s_branch L_T_k2
L_T2_pre:
    v_min_u32 v2, 8, v0
    v_lshlrev_b32 v2, 7, v2
    v_mov_b32 v32, 0
    v_mov_b32 v33, 0
    v_mov_b32 v34, 0
    v_mov_b32 v35, 0
    v_mov_b32 v36, 0
    v_mov_b32 v37, 0
    v_mov_b32 v38, 0
    v_mov_b32 v39, 0
    s_cmp_ge_u32 s5, 16
    s_cbranch_scc1 L_T2_q
L_spin_17:
    ds_read_b32 v16, v13 offset:24
    s_sub_u32 s96, s96, 1
    s_cbranch_scc1 L_end
    s_waitcnt lgkmcnt(0)
    v_cmp_gt_u32 vcc, 7, v16
    s_cbranch_vccnz L_spin_18
L_T2_q:
    buffer_load_dword v97, v2, s[32:35], s19 offen
    buffer_store_dwordx4 v[32:35], v6, s[32:35], s19 offen
    s_lshl_b32 s51, s4, 15
    s_lshl_b32 s60, s6, 13
    s_add_u32 s51, s51, s60
    s_add_u32 s51, s51, 524288
    v_lshrrev_b32 v3, 5, v0
    v_and_b32 v4, 31, v0
    v_lshlrev_b32 v2, 4, v4
    v_lshl_add_u32 v2, v3, 11, v2
    v_add_u32 v59, 4096, v2
    v_bfe_u32 v56, v0, 2, 2
    v_lshl_add_u32 v56, v7, 3, v56
    v_mul_u32_u24 v56, 1152, v56
    v_lshl_add_u32 v56, v17, 4, v56
    s_mul_i32 s56, s4, 36864
    s_add_u32 s56, s56, 1048576
    v_and_b32 v4, 1, v7
    v_mul_u32_u24 v11, 320, v3
    v_lshl_add_u32 v11, v4, 7, v11
    v_lshl_add_u32 v11, v9, 4, v11
    v_lshl_add_u32 v11, v10, 3, v11
    v_add_u32 v11, 83968, v11
    v_mov_b32 v4, v15
    v_xor_b32 v5, v1, v15
    v_mov_b32 v36, v15
    s_mov_b32 s53, 0
    s_waitcnt vmcnt(0)
    s_mov_b64 exec, 0xf0
    buffer_store_dwordx4 v[36:39], v6, s[32:35], s19 offen offset:1024
    s_mov_b64 exec, 1
    ds_add_u32 v13, v14 offset:24
    s_mov_b64 exec, -1
    s_cmp_ge_u32 s5, 16
    s_cbranch_scc1 L_fp_19
    s_cmp_eq_u32 s99, 7
    s_cbranch_scc1 L_fp_19
    s_mov_b64 s[36:37], s[20:21]
    s_mov_b32 s38, 1835008
    s_mov_b32 s39, 0x20000
    s_mov_b64 s[40:41], s[22:23]
    s_mov_b32 s42, 1835008
    s_mov_b32 s43, 0x20000
    s_lshl_b32 s61, s99, 2
    s_add_u32 s61, s61, s7
    s_mul_i32 s97, s54, 458752
    s_lshl_b32 s60, s61, 7
    s_add_u32 s97, s97, s60
    s_lshl_b32 s58, s6, 0
    v_lshrrev_b32 v12, 3, v0
    v_mul_u32_u24 v12, 3584, v12
    v_lshl_add_u32 v12, v9, 4, v12
    s_mov_b64 s[44:45], s[8:9]
    s_mov_b32 s46, 4096
    s_mov_b32 s47, 0x20000
    v_lshlrev_b32 v21, 4, v9
    v_lshl_add_u32 v21, v10, 3, v21
    v_lshl_add_u32 v21, v7, 1, v21
    s_lshl_b32 s62, s6, 10
    s_lshl_b32 s60, s54, 8
    s_add_u32 s62, s62, s60
L_spin_20:
    ds_read_b32 v16, v13 offset:100
    s_sub_u32 s96, s96, 1
    s_cbranch_scc1 L_end
    s_waitcnt lgkmcnt(0)
    v_cmp_gt_u32 vcc, 2, v16
    s_cbranch_vccnz L_spin_21
    buffer_load_ushort v22, v21, s[44:47], s62 offen
    buffer_load_ushort v23, v21, s[44:47], s62 offen offset:128
L_fp_19:
L_spin_22:
    ds_read_b32 v3, v13 offset:36
    s_sub_u32 s96, s96, 1
    s_cbranch_scc1 L_end
    s_waitcnt lgkmcnt(0)
    v_cmp_gt_u32 vcc, 2, v3
    s_cbranch_vccnz L_spin_23
    buffer_load_dword v96, v56, s[32:35], s56 offen offset:1088 sc1
    buffer_load_dwordx4 v[64:67], v2, s[32:35], s51 offen offset:0 sc1
    buffer_load_dwordx4 v[68:71], v2, s[32:35], s51 offen offset:512 sc1
    buffer_load_dwordx4 v[72:75], v2, s[32:35], s51 offen offset:1024 sc1
    buffer_load_dwordx4 v[76:79], v2, s[32:35], s51 offen offset:1536 sc1
    buffer_load_dwordx4 v[80:83], v59, s[32:35], s51 offen offset:0 sc1
    buffer_load_dwordx4 v[84:87], v59, s[32:35], s51 offen offset:512 sc1
    buffer_load_dwordx4 v[88:91], v59, s[32:35], s51 offen offset:1024 sc1
    buffer_load_dwordx4 v[92:95], v59, s[32:35], s51 offen offset:1536 sc1
    s_waitcnt vmcnt(0)
L_chk_24:
    v_xor_b32 v96, v96, v4
    v_xor_b32 v64, v64, v4
    v_xor_b32 v68, v68, v4
    v_xor_b32 v72, v72, v4
    v_xor_b32 v76, v76, v4
    v_xor_b32 v80, v80, v4
    v_xor_b32 v84, v84, v4
    v_xor_b32 v88, v88, v4
    v_xor_b32 v92, v92, v4
    v_or3_b32 v3, v96, v64, v68
    v_or3_b32 v3, v3, v72, v76
    v_or3_b32 v3, v3, v80, v84
    v_or3_b32 v3, v3, v88, v92
    v_and_b32 v3, s49, v3
    v_cmp_ne_u32 vcc, 0, v3
    s_cbranch_vccnz L_poll_25
    v_pk_add_f32 v[64:65], v[64:65], v[68:69]
    v_pk_add_f32 v[66:67], v[66:67], v[70:71]
    v_pk_add_f32 v[72:73], v[72:73], v[76:77]
    v_pk_add_f32 v[74:75], v[74:75], v[78:79]
    v_pk_add_f32 v[64:65], v[64:65], v[72:73]
    v_pk_add_f32 v[66:67], v[66:67], v[74:75]
    v_pk_add_f32 v[80:81], v[80:81], v[84:85]
    v_pk_add_f32 v[82:83], v[82:83], v[86:87]
    v_pk_add_f32 v[88:89], v[88:89], v[92:93]
    v_pk_add_f32 v[90:91], v[90:91], v[94:95]
    v_pk_add_f32 v[80:81], v[80:81], v[88:89]
    v_pk_add_f32 v[82:83], v[82:83], v[90:91]
    v_cvt_pk_bf16_f32 v64, v64, v65
    v_cvt_pk_bf16_f32 v65, v66, v67
    ds_write_b64 v11, v[64:65] offset:0
    v_cvt_pk_bf16_f32 v80, v80, v81
    v_cvt_pk_bf16_f32 v81, v82, v83
    ds_write_b64 v11, v[80:81] offset:640
    s_and_b32 s60, s51, 4194304
    v_mov_b32 v3, s60
    ds_write_b32 v13, v3 offset:8
    s_mov_b64 exec, 1
    ds_add_u32 v13, v14 offset:0
    s_mov_b64 exec, -1
L_spin_26:
    ds_read_b32 v16, v53 offset:64
    s_sub_u32 s96, s96, 1
    s_cbranch_scc1 L_end
    s_waitcnt lgkmcnt(0)
    v_cmp_gt_u32 vcc, 1, v16
    s_cbranch_vccnz L_spin_26
    ds_read_b128 v[128:131], v48 offset:0
    ds_read_b128 v[132:135], v49 offset:0
    ds_read_b128 v[136:139], v50 offset:0
    ds_read_b128 v[140:143], v51 offset:0
    ds_read_b128 v[144:147], v48 offset:4096
    ds_read_b128 v[148:151], v49 offset:4096
    ds_read_b128 v[152:155], v50 offset:4096
    ds_read_b128 v[156:159], v51 offset:4096
    ds_read_b128 v[160:163], v48 offset:8192
    ds_read_b128 v[164:167], v49 offset:8192
    ds_read_b128 v[168:171], v50 offset:8192
    ds_read_b128 v[172:175], v51 offset:8192
    ds_read_b128 v[176:179], v48 offset:12288
    ds_read_b128 v[180:183], v49 offset:12288
    ds_read_b128 v[184:187], v50 offset:12288
    ds_read_b128 v[188:191], v51 offset:12288
L_T_qk:
L_spin_27:
    ds_read_b32 v16, v13 offset:0
    ds_read_b32 v17, v13 offset:4
    s_sub_u32 s96, s96, 1
    s_cbranch_scc1 L_end
    s_waitcnt lgkmcnt(0)
    v_cmp_gt_u32 vcc, 1, v16
    s_cbranch_vccnz L_spin_27
L_T_qk2:
    ds_read_b128 v[192:195], v52 offset:0
    ds_read_b128 v[196:199], v52 offset:64
    ds_read_b128 v[200:203], v52 offset:128
    ds_read_b128 v[204:207], v52 offset:192
    v_readfirstlane_b32 s55, v17
    s_mov_b32 s62, 0x3e0293ee
    s_waitcnt lgkmcnt(3)
    v_mfma_f32_16x16x32_bf16 v[208:211], v[128:131], v[192:195], 0
    v_mfma_f32_16x16x32_bf16 v[212:215], v[144:147], v[192:195], 0
    v_mfma_f32_16x16x32_bf16 v[216:219], v[160:163], v[192:195], 0
    v_mfma_f32_16x16x32_bf16 v[220:223], v[176:179], v[192:195], 0
    s_waitcnt lgkmcnt(2)
    v_mfma_f32_16x16x32_bf16 v[208:211], v[132:135], v[196:199], v[208:211]
    v_mfma_f32_16x16x32_bf16 v[212:215], v[148:151], v[196:199], v[212:215]
    v_mfma_f32_16x16x32_bf16 v[216:219], v[164:167], v[196:199], v[216:219]
    v_mfma_f32_16x16x32_bf16 v[220:223], v[180:183], v[196:199], v[220:223]
    s_waitcnt lgkmcnt(1)
    v_mfma_f32_16x16x32_bf16 v[208:211], v[136:139], v[200:203], v[208:211]
    v_mfma_f32_16x16x32_bf16 v[212:215], v[152:155], v[200:203], v[212:215]
    v_mfma_f32_16x16x32_bf16 v[216:219], v[168:171], v[200:203], v[216:219]
    v_mfma_f32_16x16x32_bf16 v[220:223], v[184:187], v[200:203], v[220:223]
    s_waitcnt lgkmcnt(0)
    v_mfma_f32_16x16x32_bf16 v[212:215], v[156:159], v[204:207], v[212:215]
    v_mfma_f32_16x16x32_bf16 v[208:211], v[140:143], v[204:207], v[208:211]
    v_mfma_f32_16x16x32_bf16 v[216:219], v[172:175], v[204:207], v[216:219]
    v_mfma_f32_16x16x32_bf16 v[220:223], v[188:191], v[204:207], v[220:223]
    s_nop 5
    v_mov_b32_dpp v208, v212 quad_perm:[0,1,2,3] row_mask:0xf bank_mask:0x2
    v_mov_b32_dpp v209, v213 quad_perm:[0,1,2,3] row_mask:0xf bank_mask:0x2
    v_mov_b32_dpp v210, v214 quad_perm:[0,1,2,3] row_mask:0xf bank_mask:0x2
    v_mov_b32_dpp v211, v215 quad_perm:[0,1,2,3] row_mask:0xf bank_mask:0x2
    v_mov_b32_dpp v208, v216 quad_perm:[0,1,2,3] row_mask:0xf bank_mask:0x4
    v_mov_b32_dpp v209, v217 quad_perm:[0,1,2,3] row_mask:0xf bank_mask:0x4
    v_mov_b32_dpp v210, v218 quad_perm:[0,1,2,3] row_mask:0xf bank_mask:0x4
    v_mov_b32_dpp v211, v219 quad_perm:[0,1,2,3] row_mask:0xf bank_mask:0x4
    v_mov_b32_dpp v208, v220 quad_perm:[0,1,2,3] row_mask:0xf bank_mask:0x8
    v_mov_b32_dpp v209, v221 quad_perm:[0,1,2,3] row_mask:0xf bank_mask:0x8
    v_mov_b32_dpp v210, v222 quad_perm:[0,1,2,3] row_mask:0xf bank_mask:0x8
    v_mov_b32_dpp v211, v223 quad_perm:[0,1,2,3] row_mask:0xf bank_mask:0x8
    v_max3_f32 v16, v208, v209, v210
    v_max_f32 v16, v16, v211
    s_nop 1
    v_max_f32_dpp v16, v16, v16 row_ror:4 row_mask:0xf bank_mask:0xf
    s_nop 1
    v_max_f32_dpp v16, v16, v16 row_ror:8 row_mask:0xf bank_mask:0xf
    v_mov_b32 v17, v16
    s_nop 1
    v_permlane16_swap_b32 v16, v17
    v_max_f32 v16, v16, v17
    v_mov_b32 v17, v16
    s_nop 1
    v_permlane32_swap_b32 v16, v17
    v_max_f32 v16, v16, v17
    v_mul_f32 v17, s62, v16
    v_fma_f32 v208, v208, s62, -v17
    v_fma_f32 v209, v209, s62, -v17
    v_fma_f32 v210, v210, s62, -v17
    v_fma_f32 v211, v211, s62, -v17
    v_exp_f32 v208, v208
    v_exp_f32 v209, v209
    v_exp_f32 v210, v210
    v_exp_f32 v211, v211
    v_cvt_pk_bf16_f32 v18, v208, v209
    v_cvt_pk_bf16_f32 v19, v210, v211
    ds_write_b64 v54, v[18:19]
    s_mov_b64 exec, 1
    ds_add_u32 v53, v14 offset:80
    s_mov_b64 exec, 15
    ds_write_b32 v62, v17
    s_mov_b64 exec, 1
    ds_add_u32 v13, v14 offset:16
    s_mov_b64 exec, -1
    s_mov_b64 s[36:37], s[20:21]
    s_mov_b32 s38, 1835008
    s_mov_b32 s39, 0x20000
    s_mov_b64 s[40:41], s[22:23]
    s_mov_b32 s42, 1835008
    s_mov_b32 s43, 0x20000
    s_lshl_b32 s61, s99, 2
    s_add_u32 s61, s61, s7
    s_mul_i32 s97, s54, 458752
    s_lshl_b32 s60, s61, 7
    s_add_u32 s97, s97, s60
    s_lshl_b32 s58, s6, 0
    v_lshrrev_b32 v12, 3, v0
    v_mul_u32_u24 v12, 3584, v12
    v_lshl_add_u32 v12, v9, 4, v12
    s_mov_b64 s[44:45], s[8:9]
    s_mov_b32 s46, 4096
    s_mov_b32 s47, 0x20000
    v_lshl_add_u32 v4, v9, 3, v7
    v_lshl_add_u32 v4, v10, 2, v4
    v_lshlrev_b32 v21, 1, v4
    s_lshl_b32 s57, s6, 10
    s_lshl_b32 s60, s54, 8
    s_add_u32 s57, s57, s60
    s_mul_i32 s63, s54, 4608
    s_add_u32 s63, s63, 65536
    v_and_b32 v3, 1, v0
    v_lshlrev_b32 v11, 4, v3
    v_lshl_add_u32 v11, v7, 5, v11
    v_lshl_add_u32 v11, v10, 7, v11
    v_add_u32 v11, s63, v11
    v_bfe_u32 v5, v0, 1, 2
    v_mul_u32_u24 v5, 0x5555, v5
    v_mov_b32 v24, 0
    v_mov_b32 v25, 0
    v_mov_b32 v26, 0
    v_mov_b32 v27, 0
    v_mov_b32 v28, 0
    v_mov_b32 v29, 0
    v_mov_b32 v30, 0
    v_mov_b32 v31, 0
    v_xor_b32 v2, s58, v9
    v_and_b32 v3, 1, v2
    v_and_b32 v61, 1, v7
    v_lshrrev_b32 v63, 1, v7
    v_lshlrev_b32 v60, 6, v3
    v_lshl_add_u32 v60, v10, 5, v60
    v_lshl_add_u32 v60, v61, 4, v60
    v_lshl_add_u32 v60, v63, 3, v60
    v_lshrrev_b32 v2, 1, v2
    v_xor_b32 v3, 4, v2
    v_mul_u32_u24 v2, 288, v2
    v_mul_u32_u24 v3, 288, v3
    v_add3_u32 v2, v2, v60, s63
    v_add3_u32 v3, v3, v60, s63
    v_add_u32 v61, 2304, v2
    v_add_u32 v63, 2304, v3
    s_lshl_b32 s62, s54, 9
    s_add_u32 s63, s62, 101056
    v_lshl_add_u32 v4, v4, 2, s63
    s_add_u32 s63, s62, 103104
    v_lshlrev_b32 v60, 4, v8
    v_lshl_add_u32 v60, v7, 2, v60
    v_add_u32 v60, s63, v60
    s_lshl_b32 s52, s6, 14
    s_lshl_b32 s60, s54, 12
    s_add_u32 s52, s52, s60
    s_add_u32 s52, s52, 2097152
    s_lshl_b32 s60, s54, 4
    s_add_u32 s63, s60, 96768
    v_mov_b32 v62, s63
    v_lshlrev_b32 v20, 3, v0
    s_add_u32 s56, s19, 1024
    s_lshl_b32 s60, s54, 8
    s_add_u32 s19, s19, s60
L_spin_28:
    ds_read_b32 v16, v13 offset:16
    ds_read_b128 v[56:59], v62 offset:64
    s_sub_u32 s96, s96, 1
    s_cbranch_scc1 L_end
    s_waitcnt lgkmcnt(0)
    v_cmp_gt_u32 vcc, 4, v16
    s_cbranch_vccnz L_spin_28
    v_max3_f32 v33, v56, v57, v58
    v_max_f32 v33, v33, v59
    v_sub_f32 v56, v56, v33
    v_sub_f32 v57, v57, v33
    v_sub_f32 v58, v58, v33
    v_sub_f32 v59, v59, v33
    v_exp_f32 v56, v56
    v_exp_f32 v57, v57
    v_exp_f32 v58, v58
    v_exp_f32 v59, v59
    v_mov_b32 v32, v15
    v_mov_b32 v35, 0
L_spin_29:
    ds_read_b32 v16, v13 offset:44
    ds_read_b128 v[36:39], v62
    s_sub_u32 s96, s96, 1
    s_cbranch_scc1 L_end
    s_waitcnt lgkmcnt(0)
    v_cmp_gt_u32 vcc, 4, v16
    s_cbranch_vccnz L_spin_29
    v_mul_f32 v34, v36, v56
    v_fmac_f32 v34, v37, v57
    v_fmac_f32 v34, v38, v58
    v_fmac_f32 v34, v39, v59
    s_lshl_b64 exec, 1, s54
    buffer_store_dwordx4 v[32:35], v6, s[32:35], s56 offen
    s_cmp_lg_u32 s55, 0
    s_cbranch_scc1 L_dup_30
L_dupb_31:
    s_mov_b64 exec, -1
    s_cmp_ge_u32 s5, 16
    s_cbranch_scc1 L_T_noe
    s_cmp_eq_u32 s99, 7
    s_cbranch_scc1 L_T_noe
    s_xor_b32 s60, s58, 0
    s_mul_i32 s60, s60, 28672
    s_add_u32 s50, s97, s60
    buffer_load_dwordx4 v[64:67], v12, s[36:39], s50 offen
    buffer_load_dwordx4 v[72:75], v12, s[40:43], s50 offen
    s_xor_b32 s60, s58, 4
    s_mul_i32 s60, s60, 28672
    s_add_u32 s50, s97, s60
    buffer_load_dwordx4 v[96:99], v12, s[36:39], s50 offen
    buffer_load_dwordx4 v[104:107], v12, s[40:43], s50 offen
    s_xor_b32 s60, s58, 8
    s_mul_i32 s60, s60, 28672
    s_add_u32 s50, s97, s60
    buffer_load_dwordx4 v[128:131], v12, s[36:39], s50 offen
    buffer_load_dwordx4 v[136:139], v12, s[40:43], s50 offen
    s_xor_b32 s60, s58, 12
    s_mul_i32 s60, s60, 28672
    s_add_u32 s50, s97, s60
    buffer_load_dwordx4 v[160:163], v12, s[36:39], s50 offen
    buffer_load_dwordx4 v[168:171], v12, s[40:43], s50 offen
L_T_noe:
    s_mov_b32 exec_hi, 0
    s_mov_b32 exec_lo, -1
    s_barrier
    ds_read_b128 v[36:39], v55 offset:0
    ds_read_b128 v[40:43], v55 offset:2176
    ds_read_b128 v[44:47], v55 offset:4352
    ds_read_b128 v[48:51], v55 offset:6528
    s_waitcnt lgkmcnt(3)
    v_pk_mul_f32 v[36:37], v[36:37], v[56:57] op_sel:[0,0] op_sel_hi:[1,0]
    v_pk_mul_f32 v[38:39], v[38:39], v[56:57] op_sel:[0,0] op_sel_hi:[1,0]
    s_waitcnt lgkmcnt(2)
    v_pk_fma_f32 v[36:37], v[40:41], v[56:57], v[36:37] op_sel:[0,1,0] op_sel_hi:[1,1,1]
    v_pk_fma_f32 v[38:39], v[42:43], v[56:57], v[38:39] op_sel:[0,1,0] op_sel_hi:[1,1,1]
    s_waitcnt lgkmcnt(1)
    v_pk_fma_f32 v[36:37], v[44:45], v[58:59], v[36:37] op_sel:[0,0,0] op_sel_hi:[1,0,1]
    v_pk_fma_f32 v[38:39], v[46:47], v[58:59], v[38:39] op_sel:[0,0,0] op_sel_hi:[1,0,1]
    s_waitcnt lgkmcnt(0)
    v_pk_fma_f32 v[36:37], v[48:49], v[58:59], v[36:37] op_sel:[0,1,0] op_sel_hi:[1,1,1]
    v_pk_fma_f32 v[38:39], v[50:51], v[58:59], v[38:39] op_sel:[0,1,0] op_sel_hi:[1,1,1]
    v_cvt_pk_bf16_f32 v36, v36, v37
    v_cvt_pk_bf16_f32 v37, v38, v39
    v_or_b32 v36, 1, v36
    buffer_store_dwordx2 v[36:37], v20, s[32:35], s19 offen
    s_cmp_lg_u32 s55, 0
    s_cbranch_scc1 L_dup_32
L_dupb_33:
    s_mov_b32 exec_hi, -1
    s_barrier
    s_cmp_ge_u32 s5, 16
    s_cbranch_scc1 L_T_O
    s_cmp_eq_u32 s99, 7
    s_cbranch_scc1 L_fin
    s_xor_b32 s60, s58, 1
    s_mul_i32 s60, s60, 28672
    s_add_u32 s50, s97, s60
    buffer_load_dwordx4 v[68:71], v12, s[36:39], s50 offen
    buffer_load_dwordx4 v[76:79], v12, s[40:43], s50 offen
    s_xor_b32 s60, s58, 2
    s_mul_i32 s60, s60, 28672
    s_add_u32 s50, s97, s60
    buffer_load_dwordx4 v[80:83], v12, s[36:39], s50 offen
    buffer_load_dwordx4 v[88:91], v12, s[40:43], s50 offen
    s_xor_b32 s60, s58, 3
    s_mul_i32 s60, s60, 28672
    s_add_u32 s50, s97, s60
    buffer_load_dwordx4 v[84:87], v12, s[36:39], s50 offen
    buffer_load_dwordx4 v[92:95], v12, s[40:43], s50 offen
    s_xor_b32 s60, s58, 5
    s_mul_i32 s60, s60, 28672
    s_add_u32 s50, s97, s60
    buffer_load_dwordx4 v[100:103], v12, s[36:39], s50 offen
    buffer_load_dwordx4 v[108:111], v12, s[40:43], s50 offen
    ds_read_b32 v48, v13 offset:8
    s_lshr_b32 s60, s4, 2
    s_lshl_b32 s60, s60, 10
    s_add_u32 s51, s52, s60
    s_xor_b32 s52, s51, 1024
    s_and_b32 s60, s4, 3
    v_add_u32 v8, 0x10000, v6
    s_waitcnt lgkmcnt(0)
    v_or_b32 v48, v48, v7
    v_cmp_eq_u32 s[56:57], s60, v48
    s_nop 1
    v_cndmask_b32 v8, v6, v8, s[56:57]
    v_cndmask_b32 v15, v1, v15, s[56:57]
    v_mov_b32 v32, 0
    v_mov_b32 v33, 0
    v_mov_b32 v34, 0
    v_mov_b32 v35, 0
    v_mov_b32 v36, 0
    v_mov_b32 v37, 0
    v_mov_b32 v38, 0
    v_mov_b32 v39, 0
    v_mov_b32 v40, 0
    v_mov_b32 v41, 0
    v_mov_b32 v42, 0
    v_mov_b32 v43, 0
    v_mov_b32 v44, 0
    v_mov_b32 v45, 0
    v_mov_b32 v46, 0
    v_mov_b32 v47, 0
L_spin_34:
    ds_read_b32 v49, v13 offset:48
    ds_read2st64_b32 v[16:17], v60 offset0:0 offset1:1
    ds_read2st64_b32 v[52:53], v60 offset0:8 offset1:9
    ds_read2st64_b32 v[54:55], v60 offset0:16 offset1:17
    s_sub_u32 s96, s96, 1
    s_cbranch_scc1 L_end
    s_waitcnt lgkmcnt(0)
    v_cmp_gt_u32 vcc, 4, v49
    s_cbranch_vccnz L_spin_34
    s_waitcnt vmcnt(18)
    v_add_f32 v54, 1.0, v54
    v_add_f32 v55, 1.0, v55
    v_lshlrev_b32 v22, 16, v22
    v_lshlrev_b32 v23, 16, v23
    v_pk_mul_f32 v[18:19], v[16:17], v[54:55]
    v_pk_mul_f32 v[20:21], v[22:23], v[54:55]
    v_and_b32 v56, 0xffff0000, v52
    v_and_b32 v57, 0xffff0000, v53
    v_and_b32 v58, 0xffff0000, v54
    v_and_b32 v59, 0xffff0000, v55
    v_sub_f32 v56, v52, v56
    v_sub_f32 v57, v53, v57
    v_sub_f32 v58, v54, v58
    v_sub_f32 v59, v55, v59
    v_perm_b32 v52, v52, v56, s59
    v_perm_b32 v53, v53, v57, s59
    v_perm_b32 v54, v54, v58, s59
    v_perm_b32 v55, v55, v59, s59
    ds_write2_b32 v2, v54, v54 offset0:0 offset1:33
    ds_write2_b32 v3, v55, v55 offset0:0 offset1:33
    ds_write2_b32 v61, v52, v52 offset0:0 offset1:33
    ds_write2_b32 v63, v53, v53 offset0:0 offset1:33
    ds_read_b128 v[192:195], v11 offset:0
    ds_read_b128 v[196:199], v11 offset:288
    ds_read_b128 v[200:203], v11 offset:576
    ds_read_b128 v[204:207], v11 offset:864
    ds_read_b128 v[208:211], v11 offset:1152
    ds_read_b128 v[212:215], v11 offset:1440
    ds_read_b128 v[216:219], v11 offset:1728
    ds_read_b128 v[220:223], v11 offset:2016
    ds_read_b128 v[224:227], v11 offset:2304
    ds_read_b128 v[228:231], v11 offset:2592
    ds_read_b128 v[232:235], v11 offset:2880
    ds_read_b128 v[236:239], v11 offset:3168
    ds_read_b128 v[240:243], v11 offset:3456
    ds_read_b128 v[244:247], v11 offset:3744
    ds_read_b128 v[248:251], v11 offset:4032
    ds_read_b128 v[252:255], v11 offset:4320
    s_waitcnt lgkmcnt(0)
    s_waitcnt vmcnt(6)
    s_xor_b32 s60, s58, 6
    s_mul_i32 s60, s60, 28672
    s_add_u32 s50, s97, s60
    buffer_load_dwordx4 v[112:115], v12, s[36:39], s50 offen
    buffer_load_dwordx4 v[120:123], v12, s[40:43], s50 offen
    v_smfmac_f32_16x16x64_bf16 v[32:35], v[192:195], v[64:71], v5
    v_smfmac_f32_16x16x64_bf16 v[36:39], v[192:195], v[72:79], v5
    v_smfmac_f32_16x16x64_bf16 v[40:43], v[224:227], v[64:71], v5
    v_smfmac_f32_16x16x64_bf16 v[44:47], v[224:227], v[72:79], v5
    s_waitcnt vmcnt(6)
    s_xor_b32 s60, s58, 7
    s_mul_i32 s60, s60, 28672
    s_add_u32 s50, s97, s60
    buffer_load_dwordx4 v[116:119], v12, s[36:39], s50 offen
    buffer_load_dwordx4 v[124:127], v12, s[40:43], s50 offen
    s_waitcnt vmcnt(6)
    s_xor_b32 s60, s58, 9
    s_mul_i32 s60, s60, 28672
    s_add_u32 s50, s97, s60
    buffer_load_dwordx4 v[132:135], v12, s[36:39], s50 offen
    buffer_load_dwordx4 v[140:143], v12, s[40:43], s50 offen
    v_smfmac_f32_16x16x64_bf16 v[32:35], v[196:199], v[80:87], v5
    v_smfmac_f32_16x16x64_bf16 v[36:39], v[196:199], v[88:95], v5
    v_smfmac_f32_16x16x64_bf16 v[40:43], v[228:231], v[80:87], v5
    v_smfmac_f32_16x16x64_bf16 v[44:47], v[228:231], v[88:95], v5
    s_waitcnt vmcnt(6)
    s_xor_b32 s60, s58, 10
    s_mul_i32 s60, s60, 28672
    s_add_u32 s50, s97, s60
    buffer_load_dwordx4 v[144:147], v12, s[36:39], s50 offen
    buffer_load_dwordx4 v[152:155], v12, s[40:43], s50 offen
    v_smfmac_f32_16x16x64_bf16 v[32:35], v[200:203], v[96:103], v5
    v_smfmac_f32_16x16x64_bf16 v[36:39], v[200:203], v[104:111], v5
    v_smfmac_f32_16x16x64_bf16 v[40:43], v[232:235], v[96:103], v5
    v_smfmac_f32_16x16x64_bf16 v[44:47], v[232:235], v[104:111], v5
    s_waitcnt vmcnt(6)
    s_xor_b32 s60, s58, 11
    s_mul_i32 s60, s60, 28672
    s_add_u32 s50, s97, s60
    buffer_load_dwordx4 v[148:151], v12, s[36:39], s50 offen
    buffer_load_dwordx4 v[156:159], v12, s[40:43], s50 offen
    s_waitcnt vmcnt(6)
    s_xor_b32 s60, s58, 13
    s_mul_i32 s60, s60, 28672
    s_add_u32 s50, s97, s60
    buffer_load_dwordx4 v[164:167], v12, s[36:39], s50 offen
    buffer_load_dwordx4 v[172:175], v12, s[40:43], s50 offen
    v_smfmac_f32_16x16x64_bf16 v[32:35], v[204:207], v[112:119], v5
    v_smfmac_f32_16x16x64_bf16 v[36:39], v[204:207], v[120:127], v5
    v_smfmac_f32_16x16x64_bf16 v[40:43], v[236:239], v[112:119], v5
    v_smfmac_f32_16x16x64_bf16 v[44:47], v[236:239], v[120:127], v5
    s_waitcnt vmcnt(6)
    s_xor_b32 s60, s58, 14
    s_mul_i32 s60, s60, 28672
    s_add_u32 s50, s97, s60
    buffer_load_dwordx4 v[176:179], v12, s[36:39], s50 offen
    buffer_load_dwordx4 v[184:187], v12, s[40:43], s50 offen
    v_smfmac_f32_16x16x64_bf16 v[32:35], v[208:211], v[128:135], v5
    v_smfmac_f32_16x16x64_bf16 v[36:39], v[208:211], v[136:143], v5
    v_smfmac_f32_16x16x64_bf16 v[40:43], v[240:243], v[128:135], v5
    v_smfmac_f32_16x16x64_bf16 v[44:47], v[240:243], v[136:143], v5
    s_waitcnt vmcnt(6)
    s_xor_b32 s60, s58, 15
    s_mul_i32 s60, s60, 28672
    s_add_u32 s50, s97, s60
    buffer_load_dwordx4 v[180:183], v12, s[36:39], s50 offen
    buffer_load_dwordx4 v[188:191], v12, s[40:43], s50 offen
    buffer_load_dwordx4 v[48:51], v6, s[32:35], s52 offen offset:0 sc1
    buffer_load_dwordx4 v[52:55], v8, s[32:35], s51 offen offset:0 sc1
    buffer_load_dwordx4 v[56:59], v6, s[32:35], s52 offen offset:2048 sc1
    buffer_load_dwordx4 v[60:63], v8, s[32:35], s51 offen offset:2048 sc1
    s_mov_b64 exec, 1
    ds_add_u32 v13, v14 offset:52
    s_mov_b64 exec, -1
    s_lshl_b32 s63, s54, 10
    s_add_u32 s63, s63, 88064
    v_add_u32 v12, s63, v6
    s_waitcnt vmcnt(10)
    v_smfmac_f32_16x16x64_bf16 v[32:35], v[212:215], v[144:151], v5
    v_smfmac_f32_16x16x64_bf16 v[36:39], v[212:215], v[152:159], v5
    v_smfmac_f32_16x16x64_bf16 v[40:43], v[244:247], v[144:151], v5
    v_smfmac_f32_16x16x64_bf16 v[44:47], v[244:247], v[152:159], v5
    s_waitcnt vmcnt(8)
    v_smfmac_f32_16x16x64_bf16 v[32:35], v[216:219], v[160:167], v5
    v_smfmac_f32_16x16x64_bf16 v[36:39], v[216:219], v[168:175], v5
    v_smfmac_f32_16x16x64_bf16 v[40:43], v[248:251], v[160:167], v5
    v_smfmac_f32_16x16x64_bf16 v[44:47], v[248:251], v[168:175], v5
    s_waitcnt vmcnt(4)
    v_smfmac_f32_16x16x64_bf16 v[32:35], v[220:223], v[176:183], v5
    v_smfmac_f32_16x16x64_bf16 v[36:39], v[220:223], v[184:191], v5
    v_smfmac_f32_16x16x64_bf16 v[40:43], v[252:255], v[176:183], v5
    v_smfmac_f32_16x16x64_bf16 v[44:47], v[252:255], v[184:191], v5
    s_nop 4
    v_add_f32_dpp v192, v33, v32 row_ror:8 row_mask:0xf bank_mask:0x3
    s_nop 1
    v_add_f32_dpp v192, v34, v35 row_ror:8 row_mask:0xf bank_mask:0xc
    v_add_f32_dpp v193, v37, v36 row_ror:8 row_mask:0xf bank_mask:0x3
    s_nop 1
    v_add_f32_dpp v193, v38, v39 row_ror:8 row_mask:0xf bank_mask:0xc
    v_add_f32_dpp v194, v41, v40 row_ror:8 row_mask:0xf bank_mask:0x3
    s_nop 1
    v_add_f32_dpp v194, v42, v43 row_ror:8 row_mask:0xf bank_mask:0xc
    v_add_f32_dpp v195, v45, v44 row_ror:8 row_mask:0xf bank_mask:0x3
    s_nop 1
    v_add_f32_dpp v195, v46, v47 row_ror:8 row_mask:0xf bank_mask:0xc
    ds_write_b128 v12, v[192:195]
    s_mov_b64 exec, 1
    ds_add_u32 v13, v14 offset:56
    s_mov_b64 exec, -1
    s_add_u32 s60, s62, 98944
    v_lshl_add_u32 v12, v0, 3, s60
    s_lshl_b32 s60, s54, 3
    s_add_u32 s60, s60, 100992
    v_mov_b32 v40, s60
    s_branch L_chk_35
L_poll_36:
    buffer_load_dwordx4 v[48:51], v6, s[32:35], s52 offen offset:0 sc1
    buffer_load_dwordx4 v[52:55], v8, s[32:35], s51 offen offset:0 sc1
    buffer_load_dwordx4 v[56:59], v6, s[32:35], s52 offen offset:2048 sc1
    buffer_load_dwordx4 v[60:63], v8, s[32:35], s51 offen offset:2048 sc1
    s_mov_b64 exec, 1
    ds_add_u32 v13, v14 offset:52
    s_mov_b64 exec, -1
    s_sub_u32 s96, s96, 1
    s_cbranch_scc1 L_end
L_chk_35:
    s_waitcnt vmcnt(2)
    v_xor_b32 v48, v48, v1
    v_xor_b32 v52, v52, v15
    v_or_b32 v41, v48, v52
    v_pk_add_f32 v[48:49], v[48:49], v[52:53]
    v_pk_add_f32 v[50:51], v[50:51], v[54:55]
    s_nop 1
    v_permlane32_swap_b32 v48, v50
    v_permlane32_swap_b32 v49, v51
    v_pk_add_f32 v[48:49], v[48:49], v[50:51]
    s_nop 1
    v_permlane16_swap_b32 v48, v49
    v_add_f32 v32, v48, v49
    s_waitcnt vmcnt(0)
    v_xor_b32 v56, v56, v1
    v_xor_b32 v60, v60, v15
    v_or3_b32 v41, v41, v56, v60
    v_pk_add_f32 v[56:57], v[56:57], v[60:61]
    v_pk_add_f32 v[58:59], v[58:59], v[62:63]
    v_and_b32 v41, s49, v41
    v_cmp_ne_u32 vcc, 0, v41
    s_cbranch_vccnz L_poll_36
    v_permlane32_swap_b32 v56, v58
    v_permlane32_swap_b32 v57, v59
    v_pk_add_f32 v[56:57], v[56:57], v[58:59]
    ds_write_b32 v13, v13 offset:52
    s_nop 0
    v_permlane16_swap_b32 v56, v57
    v_add_f32 v33, v56, v57
    v_pk_fma_f32 v[34:35], v[32:33], v[18:19], v[20:21]
    v_and_b32 v36, 0xffff0000, v34
    v_and_b32 v37, 0xffff0000, v35
    v_sub_f32 v36, v34, v36
    v_sub_f32 v37, v35, v37
    v_perm_b32 v34, v34, v36, s59
    v_perm_b32 v35, v35, v37, s59
    ds_write2_b32 v2, v34, v34 offset0:0 offset1:33
    ds_write2_b32 v3, v35, v35 offset0:0 offset1:33
    ds_read_b128 v[192:195], v11 offset:0
    ds_read_b128 v[196:199], v11 offset:288
    ds_read_b128 v[200:203], v11 offset:576
    ds_read_b128 v[204:207], v11 offset:864
    ds_read_b128 v[208:211], v11 offset:1152
    ds_read_b128 v[212:215], v11 offset:1440
    ds_read_b128 v[216:219], v11 offset:1728
    ds_read_b128 v[220:223], v11 offset:2016
    v_pk_fma_f32 v[22:23], v[32:33], v[16:17], v[22:23]
    ds_write2_b32 v4, v22, v23 offset0:0 offset1:64
    v_add_f32 v38, v22, v23
    v_mul_f32 v39, v22, v22
    v_fmac_f32 v39, v23, v23
    s_waitcnt lgkmcnt(8)
    v_smfmac_f32_16x16x64_bf16 v[24:27], v[192:195], v[64:71], v5
    v_add_f32_dpp v38, v38, v38 row_ror:1 row_mask:0xf bank_mask:0xf
    v_smfmac_f32_16x16x64_bf16 v[28:31], v[192:195], v[72:79], v5
    v_add_f32_dpp v39, v39, v39 row_ror:1 row_mask:0xf bank_mask:0xf
    s_waitcnt lgkmcnt(7)
    v_smfmac_f32_16x16x64_bf16 v[24:27], v[196:199], v[80:87], v5
    v_add_f32_dpp v38, v38, v38 row_ror:2 row_mask:0xf bank_mask:0xf
    v_smfmac_f32_16x16x64_bf16 v[28:31], v[196:199], v[88:95], v5
    v_add_f32_dpp v39, v39, v39 row_ror:2 row_mask:0xf bank_mask:0xf
    s_waitcnt lgkmcnt(6)
    v_smfmac_f32_16x16x64_bf16 v[24:27], v[200:203], v[96:103], v5
    v_add_f32_dpp v38, v38, v38 row_ror:4 row_mask:0xf bank_mask:0xf
    v_smfmac_f32_16x16x64_bf16 v[28:31], v[200:203], v[104:111], v5
    v_add_f32_dpp v39, v39, v39 row_ror:4 row_mask:0xf bank_mask:0xf
    s_waitcnt lgkmcnt(5)
    v_smfmac_f32_16x16x64_bf16 v[24:27], v[204:207], v[112:119], v5
    v_add_f32_dpp v38, v38, v38 row_ror:8 row_mask:0xf bank_mask:0xf
    v_smfmac_f32_16x16x64_bf16 v[28:31], v[204:207], v[120:127], v5
    v_add_f32_dpp v39, v39, v39 row_ror:8 row_mask:0xf bank_mask:0xf
    s_waitcnt lgkmcnt(4)
    v_smfmac_f32_16x16x64_bf16 v[24:27], v[208:211], v[128:135], v5
    v_add_f32_dpp v38, v38, v38 row_bcast:15 row_mask:0xa bank_mask:0xf
    v_smfmac_f32_16x16x64_bf16 v[28:31], v[208:211], v[136:143], v5
    v_add_f32_dpp v39, v39, v39 row_bcast:15 row_mask:0xa bank_mask:0xf
    s_waitcnt lgkmcnt(3)
    v_smfmac_f32_16x16x64_bf16 v[24:27], v[212:215], v[144:151], v5
    v_add_f32_dpp v38, v38, v38 row_bcast:31 row_mask:0xc bank_mask:0xf
    v_smfmac_f32_16x16x64_bf16 v[28:31], v[212:215], v[152:159], v5
    v_add_f32_dpp v39, v39, v39 row_bcast:31 row_mask:0xc bank_mask:0xf
    s_waitcnt lgkmcnt(2)
    v_smfmac_f32_16x16x64_bf16 v[24:27], v[216:219], v[160:167], v5
    v_smfmac_f32_16x16x64_bf16 v[28:31], v[216:219], v[168:175], v5
    s_waitcnt lgkmcnt(1)
    v_smfmac_f32_16x16x64_bf16 v[24:27], v[220:223], v[176:183], v5
    v_smfmac_f32_16x16x64_bf16 v[28:31], v[220:223], v[184:191], v5
    s_mov_b32 exec_lo, 0
    s_mov_b32 exec_hi, 0x80000000
    ds_write_b64 v40, v[38:39]
    s_mov_b64 exec, -1
    s_nop 2
    v_add_f32_dpp v20, v25, v24 row_ror:8 row_mask:0xf bank_mask:0x3
    s_nop 1
    v_add_f32_dpp v20, v26, v27 row_ror:8 row_mask:0xf bank_mask:0xc
    v_add_f32_dpp v21, v29, v28 row_ror:8 row_mask:0xf bank_mask:0x3
    s_nop 1
    v_add_f32_dpp v21, v30, v31 row_ror:8 row_mask:0xf bank_mask:0xc
    ds_write_b64 v12, v[20:21]
    s_waitcnt lgkmcnt(0)
    s_barrier
    s_cmp_lt_u32 s99, 4
    s_cbranch_scc0 L_fin
    s_cmp_eq_u32 s54, 0
    s_cbranch_scc0 L_fin
    s_lshr_b32 s62, s61, 1
    s_and_b32 s63, s61, 1
    s_lshl_b32 s51, s61, 7
    s_add_u32 s51, s51, 109248
    v_lshlrev_b32 v18, 4, v9
    v_lshl_add_u32 v18, v7, 2, v18
    v_add_u32 v18, s51, v18
    ds_read_b32 v20, v18
    s_lshl_b32 s51, s62, 6
    s_lshl2_add_u32 s51, s63, s51
    v_lshl_add_u32 v21, v9, 3, v7
    v_add_u32 v21, s51, v21
    v_lshlrev_b32 v22, 2, v21
    v_lshlrev_b32 v21, 1, v21
    v_add_u32 v22, 101056, v22
    ds_read_b32 v23, v22
    s_lshl_b32 s51, s6, 16
    s_lshl_b32 s60, s61, 12
    s_add_u32 s51, s51, s60
    s_add_u32 s51, s51, 2621440
    s_mov_b64 s[36:37], s[30:31]
    s_mov_b32 s38, 4096
    s_mov_b32 s39, 0x20000
    s_lshl_b32 s52, s6, 10
    v_mov_b32 v44, 0
    v_mov_b32 v45, 0
    v_mov_b32 v46, 0
    v_mov_b32 v47, 0
    v_mov_b32 v17, 0
    s_mov_b32 exec_hi, 0
    v_mov_b32 v17, v1
    s_mov_b32 exec_hi, -1
    s_mov_b32 s56, 0x00ff00ff
    s_mov_b32 s57, 0x00ff00ff
    s_waitcnt lgkmcnt(0)
    s_barrier
L_poll_38:
    buffer_load_dwordx4 v[32:35], v6, s[32:35], s51 offen offset:0 sc1
    buffer_load_dwordx4 v[36:39], v6, s[32:35], s51 offen offset:1024 sc1
    buffer_load_dwordx4 v[40:43], v6, s[32:35], s51 offen offset:2048 sc1
    s_mov_b32 exec_hi, 0
    buffer_load_dwordx4 v[44:47], v6, s[32:35], s51 offen offset:3072 sc1
    s_sub_u32 s96, s96, 1
    s_cbranch_scc1 L_end
L_chk_37:
    s_mov_b32 exec_hi, -1
    s_waitcnt vmcnt(2)
    v_xor_b32 v32, v32, v1
    v_xor_b32 v36, v36, v1
    v_or_b32 v19, v32, v36
    v_pk_add_f32 v[32:33], v[32:33], v[36:37]
    v_pk_add_f32 v[34:35], v[34:35], v[38:39]
    s_waitcnt vmcnt(1)
    v_xor_b32 v40, v40, v1
    v_pk_add_f32 v[32:33], v[32:33], v[40:41]
    v_pk_add_f32 v[34:35], v[34:35], v[42:43]
    s_waitcnt vmcnt(0)
    v_xor_b32 v44, v44, v17
    v_or3_b32 v19, v19, v40, v44
    v_pk_add_f32 v[32:33], v[32:33], v[44:45]
    v_pk_add_f32 v[34:35], v[34:35], v[46:47]
    v_and_b32 v19, s49, v19
    v_cmp_ne_u32 vcc, 0, v19
    s_cbranch_vccnz L_poll_38
    v_permlane32_swap_b32 v32, v34
    v_permlane32_swap_b32 v33, v35
    v_pk_add_f32 v[32:33], v[32:33], v[34:35]
    s_nop 1
    v_permlane16_swap_b32 v32, v33
    v_add_f32 v24, v32, v33
    s_nop 1
    v_add_f32_dpp v24, v24, v24 row_ror:8 row_mask:0xf bank_mask:0xf
    v_fma_f32 v24, v24, v20, v23
    v_cvt_pk_bf16_f32 v24, v24, v24
    s_mov_b64 exec, s[56:57]
    buffer_store_short v24, v21, s[36:39], s52 offen
    s_cmp_eq_u32 s2, 0
    s_cbranch_scc0 L_fin
    s_mov_b64 exec, 1
    v_mov_b32 v24, s48
    buffer_store_dword v24, v6, s[32:35], 0 offen
    s_branch L_fin
L_A:
    v_and_b32 v0, 63, v0
    s_and_b32 s61, s5, 15
    s_lshl_b32 s62, s4, 1
    s_xor_b32 s61, s61, s62
    s_lshl_b32 s51, s6, 24
    s_lshl_b32 s60, s4, 21
    s_add_u32 s51, s51, s60
    s_lshl_b32 s60, s7, 16
    s_add_u32 s51, s51, s60
    s_lshl_b32 s60, s54, 14
    s_add_u32 s51, s51, s60
    s_lshl_b32 s60, s61, 10
    s_add_u32 s51, s51, s60
    s_add_u32 s51, s51, 1572864
    s_lshl_b32 m0, s54, 14
    s_mov_b32 s58, 0x05040100
    s_waitcnt lgkmcnt(0)
    s_load_dword s48, s[32:33], 0
    s_mov_b32 s34, 0x10000000
    s_mov_b32 s35, 0x20000
    s_movk_i32 s49, 4095
    s_mov_b32 s96, 2097152
    v_mov_b32 v13, 111296
    v_mov_b32 v14, 1
    v_lshlrev_b32 v6, 4, v0
    s_mov_b32 s59, 0x07060302
    s_cmp_eq_u32 s4, 7
    s_cselect_b32 s99, 4, s4
    s_cmp_eq_u32 s4, 4
    s_cselect_b32 s99, 7, s99
    v_lshlrev_b32 v2, 6, v7
    v_xor_b32 v2, v6, v2
    v_xor_b32 v3, 16, v2
    v_xor_b32 v4, 32, v2
    v_xor_b32 v5, 48, v2
    s_mov_b64 s[36:37], s[10:11]
    s_mov_b32 s38, 67108864
    s_mov_b32 s39, 0x20000
    s_mov_b64 s[40:41], s[12:13]
    s_mov_b32 s42, 67108864
    s_mov_b32 s43, 0x20000
    s_mov_b64 s[44:45], s[16:17]
    s_mov_b32 s46, 4194304
    s_mov_b32 s47, 0x20000
    s_cmp_ge_u32 s5, 16
    s_cbranch_scc1 L_A_O
    s_lshl_b32 s52, s4, 19
    s_lshl_b32 s60, s5, 15
    s_add_u32 s52, s52, s60
    s_lshl_b32 s60, s54, 13
    s_add_u32 s52, s52, s60
    s_barrier
    s_cmp_lt_u32 s5, 8
    s_cbranch_scc0 L_A_go
L_spin_39:
    ds_read_b32 v20, v13 offset:20
    s_sub_u32 s96, s96, 1
    s_cbranch_scc1 L_end
    s_waitcnt lgkmcnt(0)
    v_cmp_gt_u32 vcc, 1, v20
    s_cbranch_vccnz L_spin_39
L_A_go:
    buffer_load_dwordx4 v[192:195], v6, s[44:47], s52 offen
    s_add_u32 s52, s52, 1024
    buffer_load_dwordx4 v[192:195], v6, s[44:47], s52 offen
    s_add_u32 s52, s52, 1024
    buffer_load_dwordx4 v[192:195], v6, s[44:47], s52 offen
    s_add_u32 s52, s52, 1024
    buffer_load_dwordx4 v[192:195], v6, s[44:47], s52 offen
    s_add_u32 s52, s52, 1024
    buffer_load_dwordx4 v[192:195], v6, s[44:47], s52 offen
    s_add_u32 s52, s52, 1024
    buffer_load_dwordx4 v[192:195], v6, s[44:47], s52 offen
    s_add_u32 s52, s52, 1024
    buffer_load_dwordx4 v[192:195], v6, s[44:47], s52 offen
    s_add_u32 s52, s52, 1024
    buffer_load_dwordx4 v[192:195], v6, s[44:47], s52 offen
    s_add_u32 s52, s52, 1024
    s_getreg_b32 s18, hwreg(HW_REG_XCC_ID, 0, 3)
    s_lshl_b32 s18, s18, 9
    v_and_b32 v1, 3, v0
    v_mul_u32_u24 v1, 0x2d5, v1
    s_waitcnt lgkmcnt(0)
    s_add_u32 s48, s48, 1
    v_add_u32 v1, s48, v1
    v_add_u32 v15, s18, v1
    v_and_b32 v1, s49, v1
    v_and_b32 v15, s49, v15
    s_mov_b64 exec, 1
    ds_add_u32 v13, v14 offset:24
    s_mov_b64 exec, -1
    s_mul_i32 s63, s54, 4608
    s_add_u32 s63, s63, 65536
    v_mov_b32 v140, 0
    v_mov_b32 v141, 0
    v_mov_b32 v142, 0
    v_mov_b32 v143, 0
    v_mov_b32 v144, 0
    v_mov_b32 v145, 0
    v_mov_b32 v146, 0
    v_mov_b32 v147, 0
    s_lshl_b32 s61, s54, 9
    s_add_u32 s61, s61, 85504
    v_and_b32 v21, 3, v0
    v_lshrrev_b32 v22, 2, v0
    v_lshlrev_b32 v23, 4, v21
    v_lshl_add_u32 v23, v7, 6, v23
    v_add_u32 v23, s61, v23
    v_mov_b32 v148, 87552
    v_mov_b32 v149, 87552
    v_mov_b32 v150, 87552
    v_mov_b32 v151, 87552
    v_mov_b32_dpp v148, v23 quad_perm:[0,1,2,3] row_mask:0xf bank_mask:0x1
    v_mov_b32_dpp v149, v23 quad_perm:[0,1,2,3] row_mask:0xf bank_mask:0x2
    v_mov_b32_dpp v150, v23 quad_perm:[0,1,2,3] row_mask:0xf bank_mask:0x4
    v_mov_b32_dpp v151, v23 quad_perm:[0,1,2,3] row_mask:0xf bank_mask:0x8
    v_mov_b32 v16, 0x3f803f80
    v_mov_b32 v17, 0x3f803f80
    v_mov_b32 v18, 0x3f803f80
    v_mov_b32 v19, 0x3f803f80
    s_mul_i32 s61, s54, 2176
    s_add_u32 s61, s61, 88064
    v_mul_u32_u24 v152, 544, v21
    v_lshl_add_u32 v152, v22, 4, v152
    v_add_u32 v152, s61, v152
    s_lshl_b32 s61, s54, 2
    v_add_u32 v154, s61, v13
    s_add_u32 s61, s61, 96768
    v_add_u32 v153, s61, v6
    s_lshl_b32 s61, s99, 2
    s_add_u32 s61, s61, s7
    s_lshl_b32 s19, s61, 16
    s_lshl_b32 s60, s54, 8
    s_add_u32 s19, s19, s60
    v_lshlrev_b32 v128, 10, v7
    v_lshl_add_u32 v128, v8, 4, v128
    s_min_u32 s62, s54, 3
    s_lshl_b32 s56, s6, 13
    s_lshl_b32 s60, s62, 11
    s_add_u32 s56, s56, s60
    s_add_u32 s56, s56, 458752
    s_lshl_b32 s62, s54, 11
    s_add_u32 s62, s62, 103104
    v_add_u32 v129, s62, v6
    v_add_u32 v130, 88064, v6
    v_mov_b32 v131, 100992
    v_lshlrev_b32 v132, 3, v0
    v_add_u32 v132, 98944, v132
    s_lshl_b32 s60, s6, 1
    v_xor_b32 v23, s60, v9
    v_mul_u32_u24 v133, 288, v23
    v_lshl_add_u32 v133, v7, 5, v133
    v_lshl_add_u32 v133, v10, 3, v133
    v_add_u32 v133, s63, v133
    v_and_b32 v23, 1, v22
    v_lshlrev_b32 v134, 7, v23
    v_lshl_add_u32 v134, v7, 5, v134
    v_add_u32 v134, s63, v134
    v_mul_u32_u24 v135, 0x5555, v21
    v_lshlrev_b32 v136, 13, v10
    v_lshl_add_u32 v136, v7, 12, v136
    v_lshl_add_u32 v136, v9, 4, v136
    s_lshl_b32 s57, s6, 16
    s_lshl_b32 s60, s54, 14
    s_add_u32 s57, s57, s60
    s_lshl_b32 s60, s61, 7
    s_add_u32 s57, s57, s60
    s_add_u32 s57, s57, 2621440
    v_mov_b32 v139, 0
    s_waitcnt vmcnt(7)
    buffer_load_dwordx4 v2, s[36:39], s51 offen nt lds
    s_add_u32 m0, m0, 0x400
    s_waitcnt vmcnt(7)
    s_xor_b32 s50, s51, 1024
    buffer_load_dwordx4 v3, s[36:39], s50 offen nt lds
    s_add_u32 m0, m0, 0x400
    s_waitcnt vmcnt(7)
    s_xor_b32 s50, s51, 2048
    buffer_load_dwordx4 v4, s[36:39], s50 offen nt lds
    s_add_u32 m0, m0, 0x400
    s_waitcnt vmcnt(7)
    s_xor_b32 s50, s51, 3072
    buffer_load_dwordx4 v5, s[36:39], s50 offen nt lds
    s_add_u32 m0, m0, 0x400
    s_waitcnt vmcnt(7)
    s_xor_b32 s50, s51, 4096
    buffer_load_dwordx4 v2, s[36:39], s50 offen nt lds
    s_add_u32 m0, m0, 0x400
    s_waitcnt vmcnt(7)
    s_xor_b32 s50, s51, 5120
    buffer_load_dwordx4 v3, s[36:39], s50 offen nt lds
    s_add_u32 m0, m0, 0x400
    s_waitcnt vmcnt(7)
    s_xor_b32 s50, s51, 6144
    buffer_load_dwordx4 v4, s[36:39], s50 offen nt lds
    s_add_u32 m0, m0, 0x400
    s_waitcnt vmcnt(7)
    s_xor_b32 s50, s51, 7168
    buffer_load_dwordx4 v5, s[36:39], s50 offen nt lds
    s_add_u32 m0, m0, 0x400
    s_waitcnt vmcnt(7)
    s_mov_b64 exec, 1
    ds_add_u32 v13, v14 offset:28
    s_mov_b64 exec, -1
    s_xor_b32 s50, s51, 8192
    buffer_load_dwordx4 v2, s[36:39], s50 offen nt lds
    s_add_u32 m0, m0, 0x400
    s_waitcnt vmcnt(7)
    s_xor_b32 s50, s51, 9216
    buffer_load_dwordx4 v3, s[36:39], s50 offen nt lds
    s_add_u32 m0, m0, 0x400
    s_waitcnt vmcnt(7)
    s_xor_b32 s50, s51, 10240
    buffer_load_dwordx4 v4, s[36:39], s50 offen nt lds
    s_add_u32 m0, m0, 0x400
    s_waitcnt vmcnt(7)
    s_xor_b32 s50, s51, 11264
    buffer_load_dwordx4 v5, s[36:39], s50 offen nt lds
    s_add_u32 m0, m0, 0x400
    s_waitcnt vmcnt(7)
    s_xor_b32 s50, s51, 12288
    buffer_load_dwordx4 v2, s[36:39], s50 offen nt lds
    s_add_u32 m0, m0, 0x400
    s_waitcnt vmcnt(7)
    s_xor_b32 s50, s51, 13312
    buffer_load_dwordx4 v3, s[36:39], s50 offen nt lds
    s_add_u32 m0, m0, 0x400
    s_waitcnt vmcnt(7)
    s_mov_b64 exec, 1
    ds_add_u32 v13, v14 offset:100
    s_mov_b64 exec, -1
    s_xor_b32 s50, s51, 14336
    buffer_load_dwordx4 v4, s[36:39], s50 offen nt lds
    s_add_u32 m0, m0, 0x400
    s_waitcnt vmcnt(7)
    s_xor_b32 s50, s51, 15360
    buffer_load_dwordx4 v5, s[36:39], s50 offen nt lds
    s_waitcnt vmcnt(7)
    buffer_load_dwordx4 v[32:35], v6, s[40:43], s51 offen nt
    s_waitcnt vmcnt(7)
    s_mov_b64 exec, 1
    ds_add_u32 v13, v14 offset:36
    s_mov_b64 exec, -1
    s_xor_b32 s50, s51, 1024
    buffer_load_dwordx4 v[36:39], v6, s[40:43], s50 offen nt
    s_waitcnt vmcnt(7)
    s_xor_b32 s50, s51, 2048
    buffer_load_dwordx4 v[40:43], v6, s[40:43], s50 offen nt
    s_waitcnt vmcnt(7)
    s_xor_b32 s50, s51, 3072
    buffer_load_dwordx4 v[44:47], v6, s[40:43], s50 offen nt
    s_waitcnt vmcnt(7)
    s_xor_b32 s50, s51, 4096
    buffer_load_dwordx4 v[48:51], v6, s[40:43], s50 offen nt
    s_waitcnt vmcnt(7)
    s_xor_b32 s50, s51, 5120
    buffer_load_dwordx4 v[52:55], v6, s[40:43], s50 offen nt
    s_waitcnt vmcnt(7)
    s_xor_b32 s50, s51, 6144
    buffer_load_dwordx4 v[56:59], v6, s[40:43], s50 offen nt
    s_waitcnt vmcnt(7)
    s_mov_b64 exec, 1
    ds_add_u32 v154, v14 offset:64
    s_mov_b64 exec, -1
    s_xor_b32 s50, s51, 7168
    buffer_load_dwordx4 v[60:63], v6, s[40:43], s50 offen nt
    s_waitcnt vmcnt(7)
    s_xor_b32 s50, s51, 8192
    buffer_load_dwordx4 v[64:67], v6, s[40:43], s50 offen nt
    s_waitcnt vmcnt(7)
    s_xor_b32 s50, s51, 9216
    buffer_load_dwordx4 v[68:71], v6, s[40:43], s50 offen nt
    v_perm_b32 v96, v36, v32, s58
    v_perm_b32 v100, v36, v32, s59
    v_perm_b32 v104, v37, v33, s58
    v_perm_b32 v108, v37, v33, s59
    v_perm_b32 v112, v38, v34, s58
    v_perm_b32 v116, v38, v34, s59
    v_perm_b32 v120, v39, v35, s58
    v_perm_b32 v124, v39, v35, s59
    s_waitcnt vmcnt(7)
    s_xor_b32 s50, s51, 10240
    buffer_load_dwordx4 v[72:75], v6, s[40:43], s50 offen nt
    s_waitcnt vmcnt(7)
    s_xor_b32 s50, s51, 11264
    buffer_load_dwordx4 v[76:79], v6, s[40:43], s50 offen nt
    v_perm_b32 v97, v44, v40, s58
    v_perm_b32 v101, v44, v40, s59
    v_perm_b32 v105, v45, v41, s58
    v_perm_b32 v109, v45, v41, s59
    v_perm_b32 v113, v46, v42, s58
    v_perm_b32 v117, v46, v42, s59
    v_perm_b32 v121, v47, v43, s58
    v_perm_b32 v125, v47, v43, s59
    s_waitcnt vmcnt(7)
    s_xor_b32 s50, s51, 12288
    buffer_load_dwordx4 v[80:83], v6, s[40:43], s50 offen nt
    s_waitcnt vmcnt(7)
    s_xor_b32 s50, s51, 13312
    buffer_load_dwordx4 v[84:87], v6, s[40:43], s50 offen nt
    v_perm_b32 v98, v52, v48, s58
    v_perm_b32 v102, v52, v48, s59
    v_perm_b32 v106, v53, v49, s58
    v_perm_b32 v110, v53, v49, s59
    v_perm_b32 v114, v54, v50, s58
    v_perm_b32 v118, v54, v50, s59
    v_perm_b32 v122, v55, v51, s58
    v_perm_b32 v126, v55, v51, s59
    s_waitcnt vmcnt(7)
    s_xor_b32 s50, s51, 14336
    buffer_load_dwordx4 v[88:91], v6, s[40:43], s50 offen nt
    s_waitcnt vmcnt(7)
    s_xor_b32 s50, s51, 15360
    buffer_load_dwordx4 v[92:95], v6, s[40:43], s50 offen nt
    v_perm_b32 v99, v60, v56, s58
    v_perm_b32 v103, v60, v56, s59
    v_perm_b32 v107, v61, v57, s58
    v_perm_b32 v111, v61, v57, s59
    v_perm_b32 v115, v62, v58, s58
    v_perm_b32 v119, v62, v58, s59
    v_perm_b32 v123, v63, v59, s58
    v_perm_b32 v127, v63, v59, s59
    buffer_load_dwordx4 v[240:243], v6, s[32:35], s56 offen offset:0 sc1
    buffer_load_dwordx4 v[244:247], v6, s[32:35], s56 offen offset:1024 sc1
    s_mov_b64 s[44:45], s[24:25]
    s_mov_b32 s46, 1835008
    s_mov_b32 s47, 0x20000
    s_branch L_A_pv
L_A_O:
    v_lshlrev_b32 v11, 10, v7
    v_lshl_add_u32 v11, v10, 12, v11
    v_lshl_add_u32 v11, v9, 4, v11
    s_bfe_u32 s61, s5, 0x30001
    s_lshl_b32 s52, s4, 19
    s_lshl_b32 s60, s54, 17
    s_add_u32 s52, s52, s60
    s_lshl_b32 s60, s61, 7
    s_add_u32 s52, s52, s60
    s_barrier
    buffer_load_dwordx4 v2, s[36:39], s51 offen nt lds
    s_add_u32 m0, m0, 0x400
    s_xor_b32 s50, s51, 1024
    buffer_load_dwordx4 v3, s[36:39], s50 offen nt lds
    s_add_u32 m0, m0, 0x400
    s_xor_b32 s50, s51, 2048
    buffer_load_dwordx4 v4, s[36:39], s50 offen nt lds
    s_add_u32 m0, m0, 0x400
    s_xor_b32 s50, s51, 3072
    buffer_load_dwordx4 v5, s[36:39], s50 offen nt lds
    s_add_u32 m0, m0, 0x400
    s_getreg_b32 s18, hwreg(HW_REG_XCC_ID, 0, 3)
    s_lshl_b32 s18, s18, 9
    v_and_b32 v1, 3, v0
    v_mul_u32_u24 v1, 0x2d5, v1
    s_waitcnt lgkmcnt(0)
    s_add_u32 s48, s48, 1
    v_add_u32 v1, s48, v1
    v_add_u32 v15, s18, v1
    v_and_b32 v1, s49, v1
    v_and_b32 v15, s49, v15
    s_mov_b64 exec, 1
    ds_add_u32 v13, v14 offset:24
    s_mov_b64 exec, -1
    s_mul_i32 s63, s54, 4608
    s_add_u32 s63, s63, 65536
    v_mov_b32 v140, 0
    v_mov_b32 v141, 0
    v_mov_b32 v142, 0
    v_mov_b32 v143, 0
    v_mov_b32 v144, 0
    v_mov_b32 v145, 0
    v_mov_b32 v146, 0
    v_mov_b32 v147, 0
    s_lshl_b32 s61, s54, 9
    s_add_u32 s61, s61, 85504
    v_and_b32 v21, 3, v0
    v_lshrrev_b32 v22, 2, v0
    v_lshlrev_b32 v23, 4, v21
    v_lshl_add_u32 v23, v7, 6, v23
    v_add_u32 v23, s61, v23
    v_mov_b32 v148, 87552
    v_mov_b32 v149, 87552
    v_mov_b32 v150, 87552
    v_mov_b32 v151, 87552
    v_mov_b32_dpp v148, v23 quad_perm:[0,1,2,3] row_mask:0xf bank_mask:0x1
    v_mov_b32_dpp v149, v23 quad_perm:[0,1,2,3] row_mask:0xf bank_mask:0x2
    v_mov_b32_dpp v150, v23 quad_perm:[0,1,2,3] row_mask:0xf bank_mask:0x4
    v_mov_b32_dpp v151, v23 quad_perm:[0,1,2,3] row_mask:0xf bank_mask:0x8
    v_mov_b32 v16, 0x3f803f80
    v_mov_b32 v17, 0x3f803f80
    v_mov_b32 v18, 0x3f803f80
    v_mov_b32 v19, 0x3f803f80
    s_mul_i32 s61, s54, 2176
    s_add_u32 s61, s61, 88064
    v_mul_u32_u24 v152, 544, v21
    v_lshl_add_u32 v152, v22, 4, v152
    v_add_u32 v152, s61, v152
    s_lshl_b32 s61, s54, 2
    v_add_u32 v154, s61, v13
    s_add_u32 s61, s61, 96768
    v_add_u32 v153, s61, v6
    v_mov_b32 v156, 0
    v_mov_b32 v157, 0
    v_mov_b32 v158, 0
    v_mov_b32 v159, 0
    v_mul_u32_u24 v128, 1152, v7
    v_lshl_add_u32 v128, v8, 4, v128
    s_lshl_b32 s60, s54, 8
    v_add_u32 v128, s60, v128
    v_mul_u32_u24 v129, 1152, v8
    s_lshl_b32 s60, s54, 4
    v_add_u32 v129, s60, v129
    s_and_b32 s61, s5, 1
    s_lshl1_add_u32 s61, s4, s61
    s_mul_i32 s56, s61, 18432
    s_add_u32 s56, s56, 1048576
    v_and_b32 v24, 1, v0
    v_bfe_u32 v25, v0, 1, 2
    v_and_b32 v26, 1, v22
    v_and_b32 v27, 1, v7
    v_lshrrev_b32 v28, 1, v7
    v_bfe_u32 v29, v0, 1, 1
    v_lshlrev_b32 v130, 5, v25
    v_lshl_add_u32 v130, v10, 4, v130
    v_lshl_add_u32 v130, v24, 3, v130
    v_add_u32 v130, s63, v130
    v_lshlrev_b32 v23, 7, v26
    v_lshl_add_u32 v23, v7, 5, v23
    v_lshl_add_u32 v23, v10, 4, v23
    v_add_u32 v23, s63, v23
    v_mov_b32 v131, 87552
    v_mov_b32 v132, 87552
    v_mov_b32 v135, 87552
    v_mov_b32 v136, 87552
    v_mov_b32_dpp v131, v23 quad_perm:[0,1,2,3] row_mask:0xf bank_mask:0x3
    v_mov_b32_dpp v132, v23 quad_perm:[0,1,2,3] row_mask:0xf bank_mask:0xc
    v_mul_u32_u24 v133, 0x5555, v21
    s_lshl_b32 s61, s54, 9
    s_add_u32 s61, s61, 96896
    v_lshlrev_b32 v134, 8, v26
    v_lshl_add_u32 v134, v24, 7, v134
    v_lshl_add_u32 v134, v28, 6, v134
    v_lshl_add_u32 v134, v10, 4, v134
    v_lshl_add_u32 v134, v27, 3, v134
    v_lshl_add_u32 v134, v29, 2, v134
    v_add_u32 v134, s61, v134
    v_lshlrev_b32 v23, 7, v7
    v_lshl_add_u32 v23, v10, 6, v23
    v_lshl_add_u32 v23, v21, 4, v23
    v_add_u32 v23, s61, v23
    s_nop 1
    v_mov_b32_dpp v135, v23 quad_perm:[0,1,2,3] row_mask:0xf bank_mask:0x5
    v_mov_b32_dpp v136, v23 quad_perm:[0,1,2,3] row_mask:0xf bank_mask:0xa
    v_mul_u32_u24 v137, 0xaaaa, v29
    v_add_u32 v137, 0x4444, v137
    s_lshl_b32 s61, s54, 9
    s_add_u32 s61, s61, 98944
    v_lshlrev_b32 v138, 8, v28
    v_lshl_add_u32 v138, v9, 4, v138
    v_lshl_add_u32 v138, v10, 3, v138
    v_lshl_add_u32 v138, v27, 2, v138
    v_add_u32 v138, s61, v138
    s_and_b32 s61, s5, 1
    s_bfe_u32 s62, s5, 0x30001
    s_lshl_b32 s57, s61, 15
    s_lshl_b32 s60, s62, 11
    s_add_u32 s57, s57, s60
    s_lshl_b32 s60, s4, 8
    s_add_u32 s57, s57, s60
    s_add_u32 s57, s57, 2097152
    v_lshlrev_b32 v139, 14, v7
    v_lshl_add_u32 v139, v8, 4, v139
    v_add_u32 v155, 98944, v6
    s_waitcnt vmcnt(0)
    s_mov_b64 exec, 1
    ds_add_u32 v13, v14 offset:28
    s_mov_b64 exec, -1
L_spin_40:
    ds_read_b32 v20, v13 offset:32
    s_sub_u32 s96, s96, 1
    s_cbranch_scc1 L_end
    s_waitcnt lgkmcnt(0)
    v_cmp_gt_u32 vcc, 2, v20
    s_cbranch_vccnz L_spin_40
    s_xor_b32 s50, s51, 4096
    buffer_load_dwordx4 v2, s[36:39], s50 offen nt lds
    s_add_u32 m0, m0, 0x400
    s_xor_b32 s50, s51, 5120
    buffer_load_dwordx4 v3, s[36:39], s50 offen nt lds
    s_add_u32 m0, m0, 0x400
    buffer_load_dwordx4 v[32:35], v11, s[44:47], s52 offen
    s_add_u32 s52, s52, 8192
    buffer_load_dwordx4 v[36:39], v11, s[44:47], s52 offen
    s_add_u32 s52, s52, 8192
    s_waitcnt vmcnt(7)
    buffer_load_dwordx4 v[40:43], v11, s[44:47], s52 offen
    s_add_u32 s52, s52, 8192
    s_waitcnt vmcnt(7)
    buffer_load_dwordx4 v[44:47], v11, s[44:47], s52 offen
    s_add_u32 s52, s52, 8192
    s_waitcnt vmcnt(7)
    buffer_load_dwordx4 v[48:51], v11, s[44:47], s52 offen
    s_add_u32 s52, s52, 8192
    s_waitcnt vmcnt(7)
    buffer_load_dwordx4 v[52:55], v11, s[44:47], s52 offen
    s_add_u32 s52, s52, 8192
    s_waitcnt vmcnt(7)
    buffer_load_dwordx4 v[56:59], v11, s[44:47], s52 offen
    s_add_u32 s52, s52, 8192
    s_waitcnt vmcnt(7)
    buffer_load_dwordx4 v[60:63], v11, s[44:47], s52 offen
    s_add_u32 s52, s52, 8192
    s_waitcnt vmcnt(7)
    buffer_load_dwordx4 v[64:67], v11, s[44:47], s52 offen
    s_add_u32 s52, s52, 8192
    s_waitcnt vmcnt(7)
    buffer_load_dwordx4 v[68:71], v11, s[44:47], s52 offen
    s_add_u32 s52, s52, 8192
    v_perm_b32 v192, v36, v32, s58
    v_perm_b32 v200, v36, v32, s59
    v_perm_b32 v208, v37, v33, s58
    v_perm_b32 v216, v37, v33, s59
    v_perm_b32 v224, v38, v34, s58
    v_perm_b32 v232, v38, v34, s59
    v_perm_b32 v240, v39, v35, s58
    v_perm_b32 v248, v39, v35, s59
    s_waitcnt vmcnt(7)
    buffer_load_dwordx4 v[72:75], v11, s[44:47], s52 offen
    s_add_u32 s52, s52, 8192
    s_waitcnt vmcnt(7)
    buffer_load_dwordx4 v[76:79], v11, s[44:47], s52 offen
    s_add_u32 s52, s52, 8192
    v_perm_b32 v193, v44, v40, s58
    v_perm_b32 v201, v44, v40, s59
    v_perm_b32 v209, v45, v41, s58
    v_perm_b32 v217, v45, v41, s59
    v_perm_b32 v225, v46, v42, s58
    v_perm_b32 v233, v46, v42, s59
    v_perm_b32 v241, v47, v43, s58
    v_perm_b32 v249, v47, v43, s59
    s_waitcnt vmcnt(7)
    buffer_load_dwordx4 v[80:83], v11, s[44:47], s52 offen
    s_add_u32 s52, s52, 8192
    s_waitcnt vmcnt(7)
    buffer_load_dwordx4 v[84:87], v11, s[44:47], s52 offen
    s_add_u32 s52, s52, 8192
    v_perm_b32 v194, v52, v48, s58
    v_perm_b32 v202, v52, v48, s59
    v_perm_b32 v210, v53, v49, s58
    v_perm_b32 v218, v53, v49, s59
    v_perm_b32 v226, v54, v50, s58
    v_perm_b32 v234, v54, v50, s59
    v_perm_b32 v242, v55, v51, s58
    v_perm_b32 v250, v55, v51, s59
    s_waitcnt vmcnt(7)
    buffer_load_dwordx4 v[88:91], v11, s[44:47], s52 offen
    s_add_u32 s52, s52, 8192
    s_waitcnt vmcnt(7)
    buffer_load_dwordx4 v[92:95], v11, s[44:47], s52 offen
    s_add_u32 s52, s52, 8192
    v_perm_b32 v195, v60, v56, s58
    v_perm_b32 v203, v60, v56, s59
    v_perm_b32 v211, v61, v57, s58
    v_perm_b32 v219, v61, v57, s59
    v_perm_b32 v227, v62, v58, s58
    v_perm_b32 v235, v62, v58, s59
    v_perm_b32 v243, v63, v59, s58
    v_perm_b32 v251, v63, v59, s59
L_spin_41:
    ds_read_b32 v20, v13 offset:12
    s_sub_u32 s96, s96, 1
    s_cbranch_scc1 L_end
    s_waitcnt lgkmcnt(0)
    v_cmp_gt_u32 vcc, 2, v20
    s_cbranch_vccnz L_spin_41
    s_waitcnt vmcnt(7)
    s_xor_b32 s50, s51, 6144
    buffer_load_dwordx4 v4, s[36:39], s50 offen nt lds
    s_add_u32 m0, m0, 0x400
    s_waitcnt vmcnt(7)
    s_xor_b32 s50, s51, 7168
    buffer_load_dwordx4 v5, s[36:39], s50 offen nt lds
    s_add_u32 m0, m0, 0x400
    v_perm_b32 v196, v68, v64, s58
    v_perm_b32 v204, v68, v64, s59
    v_perm_b32 v212, v69, v65, s58
    v_perm_b32 v220, v69, v65, s59
    v_perm_b32 v228, v70, v66, s58
    v_perm_b32 v236, v70, v66, s59
    v_perm_b32 v244, v71, v67, s58
    v_perm_b32 v252, v71, v67, s59
    s_waitcnt vmcnt(7)
    s_xor_b32 s50, s51, 8192
    buffer_load_dwordx4 v2, s[36:39], s50 offen nt lds
    s_add_u32 m0, m0, 0x400
    s_waitcnt vmcnt(7)
    s_xor_b32 s50, s51, 9216
    buffer_load_dwordx4 v3, s[36:39], s50 offen nt lds
    s_add_u32 m0, m0, 0x400
    v_perm_b32 v197, v76, v72, s58
    v_perm_b32 v205, v76, v72, s59
    v_perm_b32 v213, v77, v73, s58
    v_perm_b32 v221, v77, v73, s59
    v_perm_b32 v229, v78, v74, s58
    v_perm_b32 v237, v78, v74, s59
    v_perm_b32 v245, v79, v75, s58
    v_perm_b32 v253, v79, v75, s59
    s_waitcnt vmcnt(7)
    s_xor_b32 s50, s51, 10240
    buffer_load_dwordx4 v4, s[36:39], s50 offen nt lds
    s_add_u32 m0, m0, 0x400
    s_waitcnt vmcnt(7)
    s_mov_b64 exec, 1
    ds_add_u32 v13, v14 offset:36
    s_mov_b64 exec, -1
    s_xor_b32 s50, s51, 11264
    buffer_load_dwordx4 v5, s[36:39], s50 offen nt lds
    s_add_u32 m0, m0, 0x400
    v_perm_b32 v198, v84, v80, s58
    v_perm_b32 v206, v84, v80, s59
    v_perm_b32 v214, v85, v81, s58
    v_perm_b32 v222, v85, v81, s59
    v_perm_b32 v230, v86, v82, s58
    v_perm_b32 v238, v86, v82, s59
    v_perm_b32 v246, v87, v83, s58
    v_perm_b32 v254, v87, v83, s59
    s_waitcnt vmcnt(7)
    s_xor_b32 s50, s51, 12288
    buffer_load_dwordx4 v2, s[36:39], s50 offen nt lds
    s_add_u32 m0, m0, 0x400
    s_waitcnt vmcnt(7)
    s_xor_b32 s50, s51, 13312
    buffer_load_dwordx4 v3, s[36:39], s50 offen nt lds
    s_add_u32 m0, m0, 0x400
    v_perm_b32 v199, v92, v88, s58
    v_perm_b32 v207, v92, v88, s59
    v_perm_b32 v215, v93, v89, s58
    v_perm_b32 v223, v93, v89, s59
    v_perm_b32 v231, v94, v90, s58
    v_perm_b32 v239, v94, v90, s59
    v_perm_b32 v247, v95, v91, s58
    v_perm_b32 v255, v95, v91, s59
    s_waitcnt vmcnt(7)
    s_xor_b32 s50, s51, 14336
    buffer_load_dwordx4 v4, s[36:39], s50 offen nt lds
    s_add_u32 m0, m0, 0x400
    s_waitcnt vmcnt(7)
    s_xor_b32 s50, s51, 15360
    buffer_load_dwordx4 v5, s[36:39], s50 offen nt lds
    s_waitcnt vmcnt(7)
    buffer_load_dwordx4 v[32:35], v6, s[40:43], s51 offen nt
    s_waitcnt vmcnt(7)
    s_xor_b32 s50, s51, 1024
    buffer_load_dwordx4 v[36:39], v6, s[40:43], s50 offen nt
    s_waitcnt vmcnt(7)
    s_xor_b32 s50, s51, 2048
    buffer_load_dwordx4 v[40:43], v6, s[40:43], s50 offen nt
    s_waitcnt vmcnt(7)
    s_xor_b32 s50, s51, 3072
    buffer_load_dwordx4 v[44:47], v6, s[40:43], s50 offen nt
    s_waitcnt vmcnt(7)
    s_xor_b32 s50, s51, 4096
    buffer_load_dwordx4 v[48:51], v6, s[40:43], s50 offen nt
    s_waitcnt vmcnt(7)
    s_xor_b32 s50, s51, 5120
    buffer_load_dwordx4 v[52:55], v6, s[40:43], s50 offen nt
    s_waitcnt vmcnt(7)
    s_xor_b32 s50, s51, 6144
    buffer_load_dwordx4 v[56:59], v6, s[40:43], s50 offen nt
    s_waitcnt vmcnt(7)
    s_mov_b64 exec, 1
    ds_add_u32 v154, v14 offset:64
    s_mov_b64 exec, -1
    s_xor_b32 s50, s51, 7168
    buffer_load_dwordx4 v[60:63], v6, s[40:43], s50 offen nt
    s_waitcnt vmcnt(7)
    s_xor_b32 s50, s51, 8192
    buffer_load_dwordx4 v[64:67], v6, s[40:43], s50 offen nt
    s_waitcnt vmcnt(7)
    s_xor_b32 s50, s51, 9216
    buffer_load_dwordx4 v[68:71], v6, s[40:43], s50 offen nt
    v_perm_b32 v96, v36, v32, s58
    v_perm_b32 v100, v36, v32, s59
    v_perm_b32 v104, v37, v33, s58
    v_perm_b32 v108, v37, v33, s59
    v_perm_b32 v112, v38, v34, s58
    v_perm_b32 v116, v38, v34, s59
    v_perm_b32 v120, v39, v35, s58
    v_perm_b32 v124, v39, v35, s59
    s_waitcnt vmcnt(7)
    s_xor_b32 s50, s51, 10240
    buffer_load_dwordx4 v[72:75], v6, s[40:43], s50 offen nt
    s_waitcnt vmcnt(7)
    s_xor_b32 s50, s51, 11264
    buffer_load_dwordx4 v[76:79], v6, s[40:43], s50 offen nt
    v_perm_b32 v97, v44, v40, s58
    v_perm_b32 v101, v44, v40, s59
    v_perm_b32 v105, v45, v41, s58
    v_perm_b32 v109, v45, v41, s59
    v_perm_b32 v113, v46, v42, s58
    v_perm_b32 v117, v46, v42, s59
    v_perm_b32 v121, v47, v43, s58
    v_perm_b32 v125, v47, v43, s59
    s_waitcnt vmcnt(7)
    s_xor_b32 s50, s51, 12288
    buffer_load_dwordx4 v[80:83], v6, s[40:43], s50 offen nt
    s_waitcnt vmcnt(7)
    s_xor_b32 s50, s51, 13312
    buffer_load_dwordx4 v[84:87], v6, s[40:43], s50 offen nt
    v_perm_b32 v98, v52, v48, s58
    v_perm_b32 v102, v52, v48, s59
    v_perm_b32 v106, v53, v49, s58
    v_perm_b32 v110, v53, v49, s59
    v_perm_b32 v114, v54, v50, s58
    v_perm_b32 v118, v54, v50, s59
    v_perm_b32 v122, v55, v51, s58
    v_perm_b32 v126, v55, v51, s59
    s_waitcnt vmcnt(7)
    s_xor_b32 s50, s51, 14336
    buffer_load_dwordx4 v[88:91], v6, s[40:43], s50 offen nt
    s_waitcnt vmcnt(7)
    s_xor_b32 s50, s51, 15360
    buffer_load_dwordx4 v[92:95], v6, s[40:43], s50 offen nt
    v_perm_b32 v99, v60, v56, s58
    v_perm_b32 v103, v60, v56, s59
    v_perm_b32 v107, v61, v57, s58
    v_perm_b32 v111, v61, v57, s59
    v_perm_b32 v115, v62, v58, s58
    v_perm_b32 v119, v62, v58, s59
    v_perm_b32 v123, v63, v59, s58
    v_perm_b32 v127, v63, v59, s59
L_A_pv:
L_spin_42:
    ds_read_b32 v20, v154 offset:80
    ds_read_b32 v21, v13 offset:8
    s_sub_u32 s96, s96, 1
    s_cbranch_scc1 L_end
    s_waitcnt lgkmcnt(0)
    v_cmp_gt_u32 vcc, 1, v20
    s_cbranch_vccnz L_spin_42
    ds_read_b128 v[160:163], v148 offset:0
    ds_read_b128 v[176:179], v148 offset:256
    ds_read_b128 v[164:167], v149 offset:0
    ds_read_b128 v[168:171], v150 offset:0
    ds_read_b128 v[172:175], v151 offset:0
    ds_read_b128 v[180:183], v149 offset:256
    ds_read_b128 v[184:187], v150 offset:256
    ds_read_b128 v[188:191], v151 offset:256
    v_readfirstlane_b32 s55, v21
    s_waitcnt lgkmcnt(6)
    v_mfma_f32_16x16x32_bf16 v[20:23], v[16:19], v[160:163], 0
    v_mfma_f32_16x16x32_bf16 v[20:23], v[16:19], v[176:179], v[20:23]
    v_mfma_f32_16x16x32_bf16 v[24:27], v[96:99], v[160:163], 0
    v_mfma_f32_16x16x32_bf16 v[28:31], v[112:115], v[160:163], 0
    s_waitcnt lgkmcnt(5)
    v_mfma_f32_16x16x32_bf16 v[24:27], v[100:103], v[164:167], v[24:27]
    v_mfma_f32_16x16x32_bf16 v[28:31], v[116:119], v[164:167], v[28:31]
    s_waitcnt lgkmcnt(4)
    v_mfma_f32_16x16x32_bf16 v[24:27], v[104:107], v[168:171], v[24:27]
    v_mfma_f32_16x16x32_bf16 v[28:31], v[120:123], v[168:171], v[28:31]
    s_waitcnt lgkmcnt(3)
    v_mfma_f32_16x16x32_bf16 v[24:27], v[108:111], v[172:175], v[24:27]
    v_mfma_f32_16x16x32_bf16 v[28:31], v[124:127], v[172:175], v[28:31]
    s_mov_b64 exec, 15
    ds_write_b32 v153, v20
    s_mov_b64 exec, 1
    ds_add_u32 v13, v14 offset:44
    s_mov_b64 exec, -1
    s_cmp_ge_u32 s5, 16
    s_cselect_b64 vcc, -1, 0
    s_waitcnt vmcnt(8)
    s_cbranch_vccz L_wb_44
    s_waitcnt vmcnt(6)
L_wb_44:
    v_perm_b32 v32, v68, v64, s58
    v_perm_b32 v36, v68, v64, s59
    v_perm_b32 v40, v69, v65, s58
    v_perm_b32 v44, v69, v65, s59
    v_perm_b32 v48, v70, v66, s58
    v_perm_b32 v52, v70, v66, s59
    v_perm_b32 v56, v71, v67, s58
    v_perm_b32 v60, v71, v67, s59
    s_waitcnt vmcnt(6)
    s_cbranch_vccz L_wb_46
    s_waitcnt vmcnt(4)
L_wb_46:
    v_perm_b32 v33, v76, v72, s58
    v_perm_b32 v37, v76, v72, s59
    v_perm_b32 v41, v77, v73, s58
    v_perm_b32 v45, v77, v73, s59
    v_perm_b32 v49, v78, v74, s58
    v_perm_b32 v53, v78, v74, s59
    v_perm_b32 v57, v79, v75, s58
    v_perm_b32 v61, v79, v75, s59
    s_waitcnt vmcnt(4) lgkmcnt(0)
    s_cbranch_vccz L_wb_48
    s_waitcnt vmcnt(2) lgkmcnt(0)
L_wb_48:
    v_perm_b32 v34, v84, v80, s58
    v_perm_b32 v38, v84, v80, s59
    v_perm_b32 v42, v85, v81, s58
    v_perm_b32 v46, v85, v81, s59
    v_perm_b32 v50, v86, v82, s58
    v_perm_b32 v54, v86, v82, s59
    v_perm_b32 v58, v87, v83, s58
    v_perm_b32 v62, v87, v83, s59
    s_waitcnt vmcnt(2)
    s_cbranch_vccz L_wb_50
    s_waitcnt vmcnt(0)
L_wb_50:
    v_perm_b32 v35, v92, v88, s58
    v_perm_b32 v39, v92, v88, s59
    v_perm_b32 v43, v93, v89, s58
    v_perm_b32 v47, v93, v89, s59
    v_mfma_f32_16x16x32_bf16 v[24:27], v[32:35], v[176:179], v[24:27]
    v_perm_b32 v51, v94, v90, s58
    v_perm_b32 v55, v94, v90, s59
    v_mfma_f32_16x16x32_bf16 v[24:27], v[36:39], v[180:183], v[24:27]
    v_perm_b32 v59, v95, v91, s58
    v_perm_b32 v63, v95, v91, s59
    v_mfma_f32_16x16x32_bf16 v[24:27], v[40:43], v[184:187], v[24:27]
    v_mfma_f32_16x16x32_bf16 v[24:27], v[44:47], v[188:191], v[24:27]
    v_mfma_f32_16x16x32_bf16 v[28:31], v[48:51], v[176:179], v[28:31]
    v_mfma_f32_16x16x32_bf16 v[28:31], v[52:55], v[180:183], v[28:31]
    v_mfma_f32_16x16x32_bf16 v[28:31], v[56:59], v[184:187], v[28:31]
    v_mfma_f32_16x16x32_bf16 v[28:31], v[60:63], v[188:191], v[28:31]
    s_nop 3
    ds_write_b128 v152, v[24:27]
    s_nop 2
    ds_write_b128 v152, v[28:31] offset:256
    s_waitcnt lgkmcnt(0)
    s_barrier
    s_cmp_lt_u32 s5, 16
    s_cbranch_scc1 L_A_notO
    v_mov_b32 v24, 0
    v_mov_b32 v25, 0
    v_mov_b32 v26, 0
    v_mov_b32 v27, 0
    v_mov_b32 v28, 0
    v_mov_b32 v29, 0
    v_mov_b32 v30, 0
    v_mov_b32 v31, 0
    v_readlane_b32 s61, v15, s54
    v_readlane_b32 s62, v1, s54
    s_add_u32 s56, s56, s55
    s_cmp_eq_u32 s55, 0
    s_cselect_b32 s61, s61, s62
    s_add_u32 s51, s56, 4608
    s_add_u32 s52, s56, 9216
    s_add_u32 s19, s56, 13824
    s_barrier
    s_mov_b64 exec, 0xffff
    buffer_load_dwordx4 v[32:35], v129, s[32:35], s56 offen offset:1024 sc1
    s_mov_b64 exec, -1
    buffer_load_dwordx4 v[64:67], v128, s[32:35], s56 offen sc1
    buffer_load_dwordx4 v[68:71], v128, s[32:35], s51 offen sc1
    buffer_load_dwordx4 v[72:75], v128, s[32:35], s52 offen sc1
    buffer_load_dwordx4 v[76:79], v128, s[32:35], s19 offen sc1
    s_mov_b64 exec, 0xffff
    s_waitcnt vmcnt(4)
    v_cmp_ne_u32 vcc, s61, v32
    s_cbranch_vccz L_O_w
L_O_s:
    s_mov_b64 exec, 0xffff
    buffer_load_dwordx4 v[32:35], v129, s[32:35], s56 offen offset:1024 sc1
    s_sub_u32 s96, s96, 1
    s_cbranch_scc1 L_end
    s_waitcnt vmcnt(0)
    v_cmp_ne_u32 vcc, s61, v32
    s_cbranch_vccnz L_O_s
    s_mov_b64 exec, -1
    buffer_load_dwordx4 v[64:67], v128, s[32:35], s56 offen sc1
    buffer_load_dwordx4 v[68:71], v128, s[32:35], s51 offen sc1
    buffer_load_dwordx4 v[72:75], v128, s[32:35], s52 offen sc1
    buffer_load_dwordx4 v[76:79], v128, s[32:35], s19 offen sc1
    s_mov_b64 exec, 0xffff
L_O_w:
    v_max_f32_dpp v17, v33, v33 quad_perm:[1,0,3,2] row_mask:0xf bank_mask:0xf
    s_nop 1
    v_max_f32_dpp v17, v17, v17 quad_perm:[2,3,0,1] row_mask:0xf bank_mask:0xf
    s_nop 1
    v_max_f32_dpp v17, v17, v17 row_half_mirror row_mask:0xf bank_mask:0xf
    v_sub_f32 v17, v33, v17
    v_exp_f32 v17, v17
    s_nop 0
    v_mul_f32 v18, v17, v34
    s_nop 1
    v_add_f32_dpp v18, v18, v18 quad_perm:[1,0,3,2] row_mask:0xf bank_mask:0xf
    s_nop 1
    v_add_f32_dpp v18, v18, v18 quad_perm:[2,3,0,1] row_mask:0xf bank_mask:0xf
    s_nop 1
    v_add_f32_dpp v18, v18, v18 row_half_mirror row_mask:0xf bank_mask:0xf
    v_rcp_f32 v18, v18
    s_nop 0
    v_mul_f32 v17, v17, v18
    v_and_b32 v18, 0xffff0000, v17
    v_sub_f32 v18, v17, v18
    v_perm_b32 v17, v17, v18, s59
    ds_write2_b32 v130, v17, v17 offset0:0 offset1:33
    s_mov_b64 exec, -1
    ds_read_b128 v[36:39], v131
    ds_read_b128 v[40:43], v132
    s_branch L_chk_51
L_poll_52:
    s_mov_b64 exec, -1
    buffer_load_dwordx4 v[64:67], v128, s[32:35], s56 offen sc1
    buffer_load_dwordx4 v[68:71], v128, s[32:35], s51 offen sc1
    buffer_load_dwordx4 v[72:75], v128, s[32:35], s52 offen sc1
    buffer_load_dwordx4 v[76:79], v128, s[32:35], s19 offen sc1
    s_sub_u32 s96, s96, 1
    s_cbranch_scc1 L_end
L_chk_51:
    s_waitcnt vmcnt(0)
    v_min3_u32 v17, v64, v66, v68
    v_min3_u32 v18, v70, v72, v74
    v_min3_u32 v17, v17, v76, v78
    v_min_u32 v17, v17, v18
    v_cmp_eq_u32 vcc, 0, v17
    s_cbranch_vccnz L_poll_52
    s_waitcnt lgkmcnt(0)
    v_smfmac_f32_16x16x64_bf16 v[156:159], v[36:39], v[64:71], v133
    v_smfmac_f32_16x16x64_bf16 v[156:159], v[40:43], v[72:79], v133
    s_nop 7
    v_cvt_pk_bf16_f32 v16, v156, v157
    v_cvt_pk_bf16_f32 v17, v158, v159
    ds_write2_b32 v134, v16, v17 offset0:0 offset1:8
    ds_read_b128 v[36:39], v135
    ds_read_b128 v[40:43], v136
    s_waitcnt lgkmcnt(1)
    v_smfmac_f32_16x16x64_bf16 v[24:27], v[36:39], v[192:199], v137
    v_smfmac_f32_16x16x64_bf16 v[28:31], v[36:39], v[208:215], v137
    v_smfmac_f32_16x16x64_bf16 v[140:143], v[36:39], v[224:231], v137
    v_smfmac_f32_16x16x64_bf16 v[144:147], v[36:39], v[240:247], v137
    s_waitcnt lgkmcnt(0)
    v_smfmac_f32_16x16x64_bf16 v[24:27], v[40:43], v[200:207], v137
    v_smfmac_f32_16x16x64_bf16 v[28:31], v[40:43], v[216:223], v137
    v_smfmac_f32_16x16x64_bf16 v[140:143], v[40:43], v[232:239], v137
    v_smfmac_f32_16x16x64_bf16 v[144:147], v[40:43], v[248:255], v137
    s_nop 4
    v_pk_add_f32 v[24:25], v[24:25], v[26:27]
    v_pk_add_f32 v[28:29], v[28:29], v[30:31]
    v_pk_add_f32 v[140:141], v[140:141], v[142:143]
    v_pk_add_f32 v[144:145], v[144:145], v[146:147]
    v_add_f32_dpp v16, v25, v24 row_ror:8 row_mask:0xf bank_mask:0x3
    v_add_f32_dpp v17, v141, v140 row_ror:8 row_mask:0xf bank_mask:0x3
    s_nop 0
    v_add_f32_dpp v16, v28, v29 row_ror:8 row_mask:0xf bank_mask:0xc
    v_add_f32_dpp v17, v144, v145 row_ror:8 row_mask:0xf bank_mask:0xc
    ds_write2_b32 v138, v16, v17 offset0:0 offset1:32
    s_mov_b32 exec_hi, 0
    s_cmp_eq_u32 s54, 0
    s_waitcnt lgkmcnt(0)
    s_barrier
    s_cbranch_scc0 L_fin
    ds_read_b128 v[64:67], v155 offset:0
    ds_read_b128 v[68:71], v155 offset:512
    ds_read_b128 v[72:75], v155 offset:1024
    ds_read_b128 v[76:79], v155 offset:1536
    s_waitcnt lgkmcnt(2)
    v_pk_add_f32 v[64:65], v[64:65], v[68:69]
    v_pk_add_f32 v[66:67], v[66:67], v[70:71]
    s_waitcnt lgkmcnt(1)
    v_pk_add_f32 v[64:65], v[64:65], v[72:73]
    v_pk_add_f32 v[66:67], v[66:67], v[74:75]
    s_waitcnt lgkmcnt(0)
    v_pk_add_f32 v[64:65], v[64:65], v[76:77]
    v_pk_add_f32 v[66:67], v[66:67], v[78:79]
    v_bfi_b32 v64, s49, v1, v64
    buffer_store_dwordx4 v[64:67], v139, s[32:35], s57 offen sc1
    s_add_u32 s57, s57, 0x10000
    s_nop 0
    v_bfi_b32 v64, s49, v15, v64
    buffer_store_dwordx4 v[64:67], v139, s[32:35], s57 offen
    s_lshl_b32 s61, s99, 2
    s_add_u32 s61, s61, s7
    s_lshl_b32 s51, s61, 7
    s_lshl_b32 s60, s6, 16
    s_add_u32 s51, s51, s60
    s_add_u32 s51, s51, 2620928
    v_lshlrev_b32 v3, 12, v8
    buffer_load_dword v97, v3, s[32:35], s51 offen
    s_branch L_fin
L_A_notO:
    s_waitcnt vmcnt(0)
    v_xor_b32 v240, v240, v1
    v_xor_b32 v244, v244, v1
    v_or_b32 v19, v240, v244
    v_and_b32 v19, s49, v19
    v_cmp_ne_u32 vcc, 0, v19
    s_cbranch_vccnz L_A_rd
    ds_write_b128 v129, v[240:243]
    ds_write_b128 v129, v[244:247] offset:1024
    s_mov_b64 exec, 1
    ds_add_u32 v13, v14 offset:48
    s_mov_b64 exec, -1
    s_barrier
    s_cmp_eq_u32 s99, 7
    s_cbranch_scc1 L_fin
    s_xor_b32 s60, s6, 0
    s_lshl_b32 s60, s60, 14
    s_add_u32 s50, s19, s60
    buffer_load_dwordx4 v[192:195], v128, s[44:47], s50 offen
    s_add_u32 s50, s50, 4096
    buffer_load_dwordx4 v[196:199], v128, s[44:47], s50 offen
    s_add_u32 s50, s50, 4096
    buffer_load_dwordx4 v[200:203], v128, s[44:47], s50 offen
    s_add_u32 s50, s50, 4096
    buffer_load_dwordx4 v[204:207], v128, s[44:47], s50 offen
L_A_rdb:
    s_xor_b32 s60, s6, 1
    s_lshl_b32 s60, s60, 14
    s_add_u32 s50, s19, s60
    buffer_load_dwordx4 v[208:211], v128, s[44:47], s50 offen
    s_add_u32 s50, s50, 4096
    buffer_load_dwordx4 v[212:215], v128, s[44:47], s50 offen
    s_add_u32 s50, s50, 4096
    buffer_load_dwordx4 v[216:219], v128, s[44:47], s50 offen
    s_add_u32 s50, s50, 4096
    buffer_load_dwordx4 v[220:223], v128, s[44:47], s50 offen
L_spin_55:
    ds_read_b32 v16, v13 offset:52
    s_sub_u32 s96, s96, 1
    s_cbranch_scc1 L_end
    s_waitcnt lgkmcnt(0)
    v_cmp_gt_u32 vcc, 4, v16
    s_cbranch_vccnz L_spin_56
    s_xor_b32 s60, s6, 2
    s_lshl_b32 s60, s60, 14
    s_add_u32 s50, s19, s60
    buffer_load_dwordx4 v[224:227], v128, s[44:47], s50 offen
    s_add_u32 s50, s50, 4096
    buffer_load_dwordx4 v[228:231], v128, s[44:47], s50 offen
    s_add_u32 s50, s50, 4096
    buffer_load_dwordx4 v[232:235], v128, s[44:47], s50 offen
    s_add_u32 s50, s50, 4096
    buffer_load_dwordx4 v[236:239], v128, s[44:47], s50 offen
L_spin_57:
    ds_read_b32 v16, v13 offset:56
    s_sub_u32 s96, s96, 1
    s_cbranch_scc1 L_end
    s_waitcnt lgkmcnt(0)
    v_cmp_gt_u32 vcc, 4, v16
    s_cbranch_vccnz L_spin_57
    ds_read_b128 v[64:67], v130 offset:0
    ds_read_b128 v[68:71], v130 offset:1024
    ds_read_b128 v[72:75], v130 offset:2048
    ds_read_b128 v[76:79], v130 offset:3072
    s_waitcnt lgkmcnt(2)
    v_pk_add_f32 v[64:65], v[64:65], v[68:69]
    v_pk_add_f32 v[66:67], v[66:67], v[70:71]
    s_waitcnt lgkmcnt(1)
    v_pk_add_f32 v[64:65], v[64:65], v[72:73]
    v_pk_add_f32 v[66:67], v[66:67], v[74:75]
    s_waitcnt lgkmcnt(0)
    v_pk_add_f32 v[64:65], v[64:65], v[76:77]
    v_pk_add_f32 v[66:67], v[66:67], v[78:79]
L_spin_58:
    ds_read_b32 v16, v13 offset:52
    s_sub_u32 s96, s96, 1
    s_cbranch_scc1 L_end
    s_waitcnt lgkmcnt(0)
    v_cmp_gt_u32 vcc, 8, v16
    s_cbranch_vccnz L_spin_58
    s_xor_b32 s60, s6, 3
    s_lshl_b32 s60, s60, 14
    s_add_u32 s50, s19, s60
    buffer_load_dwordx4 v[240:243], v128, s[44:47], s50 offen
    s_add_u32 s50, s50, 4096
    buffer_load_dwordx4 v[244:247], v128, s[44:47], s50 offen
    s_add_u32 s50, s50, 4096
    buffer_load_dwordx4 v[248:251], v128, s[44:47], s50 offen
    s_add_u32 s50, s50, 4096
    buffer_load_dwordx4 v[252:255], v128, s[44:47], s50 offen
    v_mul_f32 v64, 0xbfb8aa3b, v64
    v_mul_f32 v66, 0xbfb8aa3b, v66
    v_mov_b32 v78, 0x3b000000
    v_mov_b32 v88, 0
    v_mov_b32 v89, 0x3727c5ac
    v_mov_b32 v90, 0xbfb8aa3b
    v_mov_b32 v91, 1.0
    s_barrier
    ds_read_b128 v[68:71], v131
    ds_read_b128 v[72:75], v131 offset:16
    ds_read_b64 v[80:81], v132 offset:0
    ds_read_b64 v[82:83], v132 offset:512
    ds_read_b64 v[84:85], v132 offset:1024
    ds_read_b64 v[86:87], v132 offset:1536
    s_waitcnt lgkmcnt(4)
    v_pk_add_f32 v[68:69], v[68:69], v[70:71]
    v_pk_add_f32 v[72:73], v[72:73], v[74:75]
    v_pk_add_f32 v[68:69], v[68:69], v[72:73]
    v_pk_fma_f32 v[76:77], v[68:69], v[78:79], v[88:89] op_sel_hi:[1,0,1]
    v_fma_f32 v70, -v76, v76, v77
    v_max_f32 v70, v70, v89
    v_rsq_f32 v70, v70
    s_waitcnt lgkmcnt(0)
    v_pk_add_f32 v[80:81], v[80:81], v[82:83]
    v_pk_add_f32 v[84:85], v[84:85], v[86:87]
    v_pk_mul_f32 v[64:65], v[64:65], v[76:77] op_sel_hi:[1,0]
    v_pk_add_f32 v[80:81], v[80:81], v[84:85]
    v_pk_fma_f32 v[80:81], v[80:81], v[90:91], v[64:65] neg_lo:[0,0,1] neg_hi:[0,0,1]
    v_pk_fma_f32 v[72:73], v[80:81], v[70:71], v[66:67] op_sel_hi:[1,0,1]
    v_exp_f32 v72, v72
    s_nop 0
    v_add_f32 v72, 1.0, v72
    v_rcp_f32 v72, v72
    s_nop 0
    v_mul_f32 v72, v72, v73
    v_cvt_pk_bf16_f32 v72, v72, 0
    ds_write2_b32 v133, v72, v72 offset0:0 offset1:33
    ds_read_b128 v[96:99], v134 offset:0
    ds_read_b128 v[100:103], v134 offset:288
    ds_read_b128 v[104:107], v134 offset:576
    ds_read_b128 v[108:111], v134 offset:864
    ds_read_b128 v[112:115], v134 offset:1152
    ds_read_b128 v[116:119], v134 offset:1440
    ds_read_b128 v[120:123], v134 offset:1728
    ds_read_b128 v[124:127], v134 offset:2016
    s_waitcnt vmcnt(0)
    s_waitcnt lgkmcnt(7)
    v_smfmac_f32_16x16x64_bf16 v[140:143], v[96:99], v[192:199], v135
    s_waitcnt lgkmcnt(6)
    v_smfmac_f32_16x16x64_bf16 v[140:143], v[100:103], v[200:207], v135
    s_waitcnt lgkmcnt(5)
    v_smfmac_f32_16x16x64_bf16 v[140:143], v[104:107], v[208:215], v135
    s_waitcnt lgkmcnt(4)
    v_smfmac_f32_16x16x64_bf16 v[140:143], v[108:111], v[216:223], v135
    s_waitcnt lgkmcnt(3)
    v_smfmac_f32_16x16x64_bf16 v[140:143], v[112:115], v[224:231], v135
    s_waitcnt lgkmcnt(2)
    v_smfmac_f32_16x16x64_bf16 v[140:143], v[116:119], v[232:239], v135
    s_waitcnt lgkmcnt(1)
    v_smfmac_f32_16x16x64_bf16 v[140:143], v[120:123], v[240:247], v135
    s_waitcnt lgkmcnt(0)
    v_smfmac_f32_16x16x64_bf16 v[140:143], v[124:127], v[248:255], v135
    s_mov_b32 exec_hi, 0
    s_or_b32 s60, s99, s55
    s_cmp_eq_u32 s60, s54
    s_cbranch_scc1 L_A_loc
    s_nop 3
    v_bfi_b32 v140, s49, v1, v140
    buffer_store_dwordx4 v[140:143], v136, s[32:35], s57 offen sc1
    s_branch L_A_locb
L_A_loc:
    s_nop 3
    v_bfi_b32 v140, s49, v1, v140
    buffer_store_dwordx4 v[140:143], v136, s[32:35], s57 offen
L_A_locb:
    s_xor_b32 s99, s99, 1
    s_cmp_eq_u32 s54, s99
    s_cbranch_scc0 L_A_nw
    s_waitcnt vmcnt(0)
L_A_nw:
    s_barrier
L_fin:
L_end:
    s_endpgm
L_spin_2:
    s_sleep 1
    s_branch L_spin_1
L_spin_7:
    s_sleep 1
    s_branch L_spin_6
L_T_late:
    v_bfi_b32 v28, s49, v1, v28
    buffer_store_dwordx4 v[28:31], v2, s[32:35], s51 offen sc1
    s_branch L_T_k
L_dup_15:
    s_add_u32 s50, s51, 4194304
    s_nop 1
    v_bfi_b32 v28, s49, v1, v28
    buffer_store_dwordx4 v[28:31], v2, s[32:35], s50 offen sc1
    s_nop 1
    s_branch L_dupb_16
L_spin_18:
    s_sleep 1
    s_branch L_spin_17
L_spin_21:
    s_sleep 1
    s_branch L_spin_20
L_spin_23:
    s_sleep 1
    s_branch L_spin_22
L_poll_25:
    s_add_u32 s53, s53, 1
    s_cmp_lt_u32 s53, 64
    s_cbranch_scc1 L_r3x
    s_cmp_gt_u32 s53, 64
    s_cbranch_scc1 L_r3t
    s_add_u32 s50, s19, 4194304
    v_mov_b32 v36, v1
    buffer_store_dwordx4 v[32:35], v6, s[32:35], s50 offen sc1
    s_waitcnt vmcnt(0)
    s_mov_b64 exec, 0xf0
    buffer_store_dwordx4 v[36:39], v6, s[32:35], s50 offen offset:1024 sc1
    s_mov_b64 exec, 1
    ds_add_u32 v13, v14 offset:4
    s_mov_b64 exec, -1
L_r3t:
    s_xor_b32 s51, s51, 4194304
    s_xor_b32 s56, s56, 4194304
    v_xor_b32 v4, v4, v5
L_r3x:
    buffer_load_dword v96, v56, s[32:35], s56 offen offset:1088 sc1
    buffer_load_dwordx4 v[64:67], v2, s[32:35], s51 offen offset:0 sc1
    buffer_load_dwordx4 v[68:71], v2, s[32:35], s51 offen offset:512 sc1
    buffer_load_dwordx4 v[72:75], v2, s[32:35], s51 offen offset:1024 sc1
    buffer_load_dwordx4 v[76:79], v2, s[32:35], s51 offen offset:1536 sc1
    buffer_load_dwordx4 v[80:83], v59, s[32:35], s51 offen offset:0 sc1
    buffer_load_dwordx4 v[84:87], v59, s[32:35], s51 offen offset:512 sc1
    buffer_load_dwordx4 v[88:91], v59, s[32:35], s51 offen offset:1024 sc1
    buffer_load_dwordx4 v[92:95], v59, s[32:35], s51 offen offset:1536 sc1
    s_sub_u32 s96, s96, 1
    s_cbranch_scc1 L_end
    s_waitcnt vmcnt(0)
    s_branch L_chk_24
L_dup_30:
    s_add_u32 s50, s56, 4194304
    s_nop 1
    v_bfi_b32 v32, s49, v1, v32
    buffer_store_dwordx4 v[32:35], v6, s[32:35], s50 offen sc1
    s_nop 1
    s_branch L_dupb_31
L_dup_32:
    s_add_u32 s50, s19, 4194304
    s_nop 1
    buffer_store_dwordx2 v[36:37], v20, s[32:35], s50 offen sc1
    s_nop 1
    s_branch L_dupb_33
L_T_O:
    s_barrier
    s_branch L_fin
L_poll_54:
    buffer_load_dwordx4 v[240:243], v6, s[32:35], s56 offen offset:0 sc1
    buffer_load_dwordx4 v[244:247], v6, s[32:35], s56 offen offset:1024 sc1
    s_sub_u32 s96, s96, 1
    s_cbranch_scc1 L_end
    s_waitcnt vmcnt(0)
    s_branch L_chk_53
L_A_rd:
    s_barrier
    s_cmp_eq_u32 s99, 7
    s_cbranch_scc1 L_fin
    buffer_load_dwordx4 v[240:243], v6, s[32:35], s56 offen offset:0 sc1
    buffer_load_dwordx4 v[244:247], v6, s[32:35], s56 offen offset:1024 sc1
    s_xor_b32 s60, s6, 0
    s_lshl_b32 s60, s60, 14
    s_add_u32 s50, s19, s60
    buffer_load_dwordx4 v[192:195], v128, s[44:47], s50 offen
    s_add_u32 s50, s50, 4096
    buffer_load_dwordx4 v[196:199], v128, s[44:47], s50 offen
    s_add_u32 s50, s50, 4096
    buffer_load_dwordx4 v[200:203], v128, s[44:47], s50 offen
    s_add_u32 s50, s50, 4096
    buffer_load_dwordx4 v[204:207], v128, s[44:47], s50 offen
    s_waitcnt vmcnt(4)
L_chk_53:
    v_xor_b32 v240, v240, v1
    v_xor_b32 v244, v244, v1
    v_or_b32 v19, v240, v244
    v_and_b32 v19, s49, v19
    v_cmp_ne_u32 vcc, 0, v19
    s_cbranch_vccnz L_poll_54
    ds_write_b128 v129, v[240:243]
    ds_write_b128 v129, v[244:247] offset:1024
    s_mov_b64 exec, 1
    ds_add_u32 v13, v14 offset:48
    s_mov_b64 exec, -1
    s_branch L_A_rdb
L_spin_56:
    s_sleep 1
    s_branch L_spin_55
L_codeend:
.section .rodata,"a"
.p2align 6
.amdhsa_kernel adaLN_cond__sliding_block_cached__glu_gated_glu__decode_kernel
  .amdhsa_next_free_vgpr 256
  .amdhsa_next_free_sgpr 102
  .amdhsa_accum_offset 256
  .amdhsa_group_segment_fixed_size 0
  .amdhsa_kernarg_size 112
  .amdhsa_user_sgpr_count 2
  .amdhsa_user_sgpr_kernarg_segment_ptr 1
  .amdhsa_system_sgpr_workgroup_id_x 1
  .amdhsa_float_denorm_mode_32 3
.end_amdhsa_kernel
```
